```python
import torch

def _softmax(x, axis=-1):
    return torch.softmax(x, dim=axis)
def _gelu(x):
    return torch.nn.functional.gelu(x, approximate="tanh")
def _silu(x):
    return torch.nn.functional.silu(x)
def _sigmoid(x):
    return torch.sigmoid(x)
def _layernorm(x, axis=-1, eps=1e-5):
    m = x.mean(dim=axis, keepdim=True)
    v = x.var(dim=axis, keepdim=True, unbiased=False)
    return (x - m) / torch.sqrt(v + eps)
def _scatter_add(tgt, idx, src, axis=0):
    return tgt.clone().index_add_(axis, idx, src)
def _segment_sum(src, seg, n):
    out = torch.zeros((n,) + src.shape[1:], dtype=src.dtype)
    return out.index_add_(0, seg, src)
def _pad(x, pw):
    flat = tuple(v for pair in reversed(pw) for v in pair)
    return torch.nn.functional.pad(x, flat)

kernel_name = 'concat_heads__linear_attn_block__linear_kernel_hedgehog__prompt'

def setup_inputs():

    _w = (lambda a: (lambda t: t.to(torch.bfloat16) if t.is_floating_point() else t)(torch.as_tensor(a)))
    def _A_setup():
        B, S, D = 1, 2048, 448
        return {
            "x": _w((lambda *s: torch.randn(*s, dtype=torch.bfloat16) * 0.05)(B, S, D)),
            "wqkv": _w((lambda *s: torch.randn(*s, dtype=torch.bfloat16) * 0.8)(D, 3 * D)),
            "wo": _w((lambda *s: torch.randn(*s, dtype=torch.bfloat16) * 0.4)(D, D)),
        }
    _A_in = _A_setup()

    def _B_setup():
        B, S, D, H = 1, 2048, 448, 16
        Dh = D // H
        return {
            "x": _w((lambda *s: torch.randn(*s, dtype=torch.bfloat16) * 0.4)(B, S, D)),
            "wqkv": _w((lambda *s: torch.randn(*s, dtype=torch.bfloat16) * 0.4)(D, 3 * D)),
            "w_phi": _w((lambda *s: torch.randn(*s, dtype=torch.bfloat16) * 0.4)(H, Dh, Dh) * (Dh ** -0.5)),
            "wo": _w((lambda *s: torch.randn(*s, dtype=torch.bfloat16) * 0.05)(D, D)),
        }
    _B_in = _B_setup()

    return {
        "A_x": _A_in["x"],
        "A_wqkv": _A_in["wqkv"],
        "A_wo": _A_in["wo"],
        "B_x": _B_in["x"],
        "B_wqkv": _B_in["wqkv"],
        "B_w_phi": _B_in["w_phi"],
        "B_wo": _B_in["wo"],
    }

def reference(A_x, A_wqkv, A_wo, B_x, B_wqkv, B_w_phi, B_wo):
    def _A_ref(x, wqkv, wo):
        B, S, D = x.shape
        H = 16; Dh = D // H
        qkv = (lambda x, *d: x.permute(*d))((x @ wqkv).reshape(B, S, 3, H, Dh), 2, 0, 3, 1, 4)
        q, k, v = qkv[0], qkv[1], qkv[2]
        phi = lambda t: torch.where(t > 0, t + 1, torch.exp(t)) + 1e-6
        pq, pk = phi(q), phi(k)
        kv = torch.einsum("bhsd,bhse->bhde", pk, v)
        z = torch.einsum("bhsd->bhd", pk)
        num = torch.einsum("bhqd,bhde->bhqe", pq, kv)
        den = torch.einsum("bhqd,bhd->bhq", pq, z)[..., None] + 1e-6
        o = num / den
        return (lambda x, *d: x.permute(*d))(o, 0, 2, 1, 3).reshape(B, S, D) @ wo

    def _B_ref(x, wqkv, w_phi, wo):
        B, S, D = x.shape
        H = 16; Dh = D // H
        qkv = (lambda x, *d: x.permute(*d))((x @ wqkv).reshape(B, S, 3, H, Dh), 2, 0, 3, 1, 4)
        q, k, v = qkv[0], qkv[1], qkv[2]
        pq = torch.einsum("bhsd,hdf->bhsf", q, w_phi)
        pk = torch.einsum("bhsd,hdf->bhsf", k, w_phi)
        phi_q = torch.concatenate([_softmax(pq, axis=-1), _softmax(-pq, axis=-1)], axis=-1)
        phi_k = torch.concatenate([_softmax(pk, axis=-1), _softmax(-pk, axis=-1)], axis=-1)
        kv = torch.einsum("bhsf,bhsd->bhfd", phi_k, v)
        z  = torch.einsum("bhsf->bhf", phi_k)
        num = torch.einsum("bhqf,bhfd->bhqd", phi_q, kv)
        den = torch.einsum("bhqf,bhf->bhq", phi_q, z)[..., None] + 1e-6
        o = num / den
        return (lambda x, *d: x.permute(*d))(o, 0, 2, 1, 3).reshape(B, S, D) @ wo

    a = _A_ref(A_x, A_wqkv, A_wo)
    b = _B_ref(B_x, B_wqkv, B_w_phi, B_wo)
    return torch.concatenate([a, b], axis=-1)
```

```asm
; @launch grid=(256,1,1) block=(512,1,1) lds=163840
.amdgcn_target "amdgcn-amd-amdhsa--gfx950"
.text
.globl concat_heads__linear_attn_block__linear_kernel_hedgehog__prompt_kernel
.p2align 12
.p2align 8
.type concat_heads__linear_attn_block__linear_kernel_hedgehog__prompt_kernel,@function
concat_heads__linear_attn_block__linear_kernel_hedgehog__prompt_kernel:
    s_load_dwordx16 s[36:51], s[0:1], 0
    s_load_dwordx2 s[54:55], s[0:1], 72
    s_cmp_ge_u32 s2, 256
    s_cbranch_scc1 L_end
    v_lshrrev_b32 v32, 6, v0
    s_lshr_b32 s75, s2, 3
    v_and_b32 v1, 63, v0
    v_readfirstlane_b32 s32, v32
    s_getpc_b64 s[4:5]
L_pc:
    s_bitcmp1_b32 s2, 2
    s_cselect_b32 s64, L_A-L_pc, 0
    s_lshl_b32 s65, s75, 9
    s_add_u32 s64, s64, s65
    s_mov_b32 s6, L_end-L_pc
    s_mov_b32 s7, 0x20000
    v_lshlrev_b32 v33, 7, v1
    s_cmp_lg_u32 s32, 7
    s_cbranch_scc1 L_nopf
    s_mov_b64 exec, 0xff
    buffer_load_dword v28, v33, s[4:7], s64 offen
    s_mov_b64 exec, -1
L_nopf:
    s_and_b32 s33, s75, 7
    s_lshr_b32 s101, s75, 3
    s_and_b32 s67, s2, 3
    s_lshl2_add_u32 s34, s67, s101
    s_lshl1_add_u32 s35, s101, s33
    s_cmp_ge_u32 s35, 7
    s_cselect_b32 s65, 7, 0
    s_sub_u32 s35, s35, s65
    v_lshrrev_b32 v32, 3, v1
    v_and_b32 v33, 7, v1
    v_lshrrev_b32 v34, 4, v1
    v_mul_u32_u24 v2, 896, v32
    v_xor_b32 v35, v33, v34
    v_lshl_add_u32 v2, v35, 4, v2
    v_and_b32 v34, 1, v34
    v_lshlrev_b32 v34, 2, v34
    v_xor_b32 v33, v33, v34
    v_min_u32 v33, 6, v33
    v_mul_u32_u24 v32, 2688, v32
    s_mul_i32 s65, s33, 112
    v_lshl_add_u32 v32, v33, 4, v32
    v_xor_b32 v35, 64, v2
    v_add_u32 v6, s65, v32
    v_add_u32 v3, 6144, v35
    s_lshl3_add_u32 s65, s34, s32
    s_mul_i32 s58, s65, 14336
    s_lshl_b32 s5, s32, 10
    s_mul_i32 s59, s5, 21
    s_add_u32 s60, s5, 106496
    s_lshl_b32 s61, s32, 11
    s_mov_b32 s10, 1835008
    s_mov_b32 s11, 0x20000
    s_mov_b32 s14, 1204224
    s_mov_b32 s15, 0x20000
    s_lshl_b32 s78, s35, 12
    s_add_u32 s79, s78, 4096
    s_cmp_eq_u32 s35, 6
    s_cselect_b32 s79, 0, s79
    s_bitcmp1_b32 s2, 2
    s_waitcnt lgkmcnt(0)
    s_cselect_b32 s8, s36, s42
    s_cselect_b32 s9, s37, s43
    s_cselect_b32 s12, s38, s44
    s_cselect_b32 s13, s39, s45
    v_lshlrev_b32 v13, 4, v1
    s_cbranch_scc1 L_noph
    s_cmp_lt_u32 s32, 4
    s_cbranch_scc1 L_noph
    s_mov_b32 s28, s46
    s_mov_b32 s29, s47
    s_mov_b32 s30, 25088
    s_mov_b32 s31, 0x20000
    s_add_u32 m0, s5, 155648
    s_mul_i32 s65, s33, 3136
    s_add_u32 s65, s65, s5
    s_sub_u32 s65, s65, 4096
    buffer_load_dwordx4 v13, s[28:31], s65 offen lds
L_noph:
    s_mul_i32 s65, s78, 42
    s_add_u32 m0, s60, -896
    s_add_u32 s65, s65, s59
    buffer_load_dwordx4 v6, s[12:15], s65 offen offset:896 lds
    s_lshr_b32 s64, s78, 5
    s_add_u32 m0, s61, 57344
    s_add_u32 s64, s64, s58
    buffer_load_dwordx4 v2, s[8:11], s64 offen lds
    buffer_load_dwordx4 v3, s[8:11], s64 offen offset:1024 lds
    s_mov_b32 s20, s54
    s_mov_b32 s21, s55
    s_mov_b32 s22, 0x10000000
    s_mov_b32 s23, 0x20000
    s_bfe_u32 s64, s2, 0x10002
    s_lshl_b32 s64, s64, 8
    s_xor_b32 s64, s64, 256
    s_mov_b64 exec, 1
    buffer_load_dword v14, v13, s[20:23], s64 offen sc1
    s_mov_b64 exec, -1
    s_add_u32 s62, s79, 4096
    s_cmp_eq_u32 s62, 28672
    s_cselect_b32 s62, 0, s62
    s_bitcmp1_b32 s2, 2
    s_cbranch_scc1 L_A
L_B:
    s_mov_b32 s16, s48
    s_mov_b32 s17, s49
    s_mov_b32 s18, 401408
    s_mov_b32 s19, 0x20000
    s_mov_b32 s24, s50
    s_mov_b32 s25, s51
    s_mov_b32 s26, 3670016
    s_mov_b32 s27, 0x20000
    s_mov_b32 s36, s78
    s_mov_b32 s37, s79
    s_mov_b32 s38, s62
    s_add_u32 s39, s38, 4096
    s_cmp_eq_u32 s39, 28672
    s_cselect_b32 s39, 0, s39
    s_add_u32 s40, s39, 4096
    s_cmp_eq_u32 s40, 28672
    s_cselect_b32 s40, 0, s40
    s_add_u32 s41, s40, 4096
    s_cmp_eq_u32 s41, 28672
    s_cselect_b32 s41, 0, s41
    s_add_u32 s42, s41, 4096
    s_cmp_eq_u32 s42, 28672
    s_cselect_b32 s42, 0, s42
    s_lshr_b32 s52, s32, 2
    s_and_b32 s53, s32, 3
    v_and_b32 v32, 31, v1
    v_lshrrev_b32 v33, 5, v1
    v_bfe_u32 v34, v1, 1, 3
    v_xor_b32 v34, v34, v33
    v_lshlrev_b32 v35, 7, v32
    v_lshl_add_u32 v35, v34, 4, v35
    s_lshl_b32 s64, s53, 12
    s_add_u32 s64, s64, 57344
    v_add_u32 v7, s64, v35
    v_xor_b32 v8, 32, v7
    v_xor_b32 v9, 64, v7
    v_xor_b32 v10, 96, v7
    v_bfe_u32 v34, v1, 2, 2
    v_lshl_add_u32 v34, v33, 3, v34
    v_bfe_u32 v35, v1, 4, 1
    v_and_b32 v32, 3, v1
    v_lshl_add_u32 v35, v35, 2, v32
    v_min_u32 v35, 6, v35
    s_mul_i32 s64, s52, 7
    v_add_lshl_u32 v35, v35, s64, 3
    v_bfe_u32 v32, v1, 3, 1
    v_lshlrev_b32 v32, 6, v32
    v_xor_b32 v35, v35, v32
    v_lshl_add_u32 v16, v34, 7, v35
    v_add_u32 v11, 106496, v16
    v_add_u32 v12, 57344, v16
    s_mov_b32 s74, 0x358637bd
    v_and_b32 v44, 7, v1
    v_min_u32 v44, 6, v44
    v_bfe_u32 v45, v1, 3, 2
    v_mad_u32_u24 v44, v45, 7, v44
    v_mul_u32_u24 v45, 224, v33
    v_lshl_add_u32 v44, v44, 1, v45
    s_mul_i32 s64, s52, 1568
    s_add_u32 s64, s64, 159744
    v_add_u32 v44, s64, v44
    s_mov_b32 s70, 0
    s_mov_b32 s71, -1
    s_mul_i32 s65, s37, 42
    s_add_u32 m0, s60, 7296
    s_add_u32 s65, s65, s59
    buffer_load_dwordx4 v6, s[12:15], s65 offen offset:896 lds
    s_waitcnt vmcnt(5)
    s_barrier
    ds_read_u16 v240, v44 offset:0
    ds_read_u16 v36, v44 offset:56
    ds_read_u16 v241, v44 offset:112
    ds_read_u16 v37, v44 offset:168
    ds_read_u16 v242, v44 offset:448
    ds_read_u16 v38, v44 offset:504
    ds_read_u16 v243, v44 offset:560
    ds_read_u16 v39, v44 offset:616
    s_waitcnt lgkmcnt(1)
    ds_read_u16 v244, v44 offset:896
    ds_read_u16 v40, v44 offset:952
    ds_read_u16 v245, v44 offset:1008
    ds_read_u16 v41, v44 offset:1064
    ds_read_u16 v246, v44 offset:1344
    ds_read_u16 v42, v44 offset:1400
    ds_read_u16 v247, v44 offset:1456
    ds_read_u16 v43, v44 offset:1512
    s_waitcnt lgkmcnt(0)
    v_lshl_or_b32 v240, v36, 16, v240
    v_lshl_or_b32 v241, v37, 16, v241
    v_lshl_or_b32 v242, v38, 16, v242
    v_lshl_or_b32 v243, v39, 16, v243
    v_lshl_or_b32 v244, v40, 16, v244
    v_lshl_or_b32 v245, v41, 16, v245
    v_lshl_or_b32 v246, v42, 16, v246
    v_lshl_or_b32 v247, v43, 16, v247
    v_cndmask_b32 v246, v246, 0, s[70:71]
    v_cndmask_b32 v247, v247, 0, s[70:71]
    s_lshr_b32 s64, s37, 5
    s_add_u32 m0, s61, 73728
    s_add_u32 s64, s64, s58
    buffer_load_dwordx4 v2, s[8:11], s64 offen lds
    buffer_load_dwordx4 v3, s[8:11], s64 offen offset:1024 lds
    s_waitcnt vmcnt(3)
    s_barrier
    ds_read_b128 v[128:131], v7 offset:0
    ds_read_b64_tr_b16 v[48:49], v11 offset:0
    ds_read_b64_tr_b16 v[50:51], v11 offset:512
    ds_read_b128 v[132:135], v8 offset:0
    ds_read_b64_tr_b16 v[52:53], v11 offset:2048
    ds_read_b64_tr_b16 v[54:55], v11 offset:2560
    ds_read_b128 v[136:139], v9 offset:0
    ds_read_b64_tr_b16 v[56:57], v11 offset:4096
    ds_read_b64_tr_b16 v[58:59], v11 offset:4608
    ds_read_b128 v[140:143], v10 offset:0
    ds_read_b64_tr_b16 v[60:61], v11 offset:6144
    ds_read_b64_tr_b16 v[62:63], v11 offset:6656
    s_waitcnt lgkmcnt(9)
    v_mfma_f32_32x32x16_bf16 v[64:79], v[48:51], v[128:131], 0
    s_mov_b32 s70, 0
    s_mov_b32 s71, -1
    s_mov_b32 s72, 0x3fb8aa3b
    s_mov_b32 s96, 0xffff
    v_readfirstlane_b32 s29, v14
    s_getreg_b32 s98, hwreg(HW_REG_XCC_ID, 0, 4)
    s_lshl3_add_u32 s3, s34, s33
    s_lshr_b32 s30, s29, 16
    s_mul_i32 s65, s38, 42
    s_add_u32 m0, s60, 15488
    s_add_u32 s65, s65, s59
    buffer_load_dwordx4 v6, s[12:15], s65 offen offset:896 lds
    s_lshr_b32 s64, s38, 5
    s_add_u32 m0, s61, 90112
    s_add_u32 s64, s64, s58
    buffer_load_dwordx4 v2, s[8:11], s64 offen lds
    buffer_load_dwordx4 v3, s[8:11], s64 offen offset:1024 lds
    s_waitcnt lgkmcnt(6)
    v_mfma_f32_32x32x16_bf16 v[64:79], v[52:55], v[132:135], v[64:79]
    s_add_u32 s29, s29, 1
    s_and_b32 s29, s29, 0x3fff
    s_add_u32 s56, s29, 1
    s_and_b32 s56, s56, 0x3fff
    s_xor_b32 s30, s30, s29
    s_and_b32 s30, s30, 0xdfff
    s_cselect_b32 s56, s29, s56
    s_lshl_b32 s57, s56, 16
    s_waitcnt lgkmcnt(0)
    v_mfma_f32_32x32x16_bf16 v[64:79], v[56:59], v[136:139], v[64:79]
    s_waitcnt vmcnt(3)
    s_barrier
    ds_read_b128 v[144:147], v7 offset:16384
    ds_read_b64_tr_b16 v[48:49], v11 offset:8192
    ds_read_b64_tr_b16 v[50:51], v11 offset:8704
    ds_read_b128 v[148:151], v8 offset:16384
    ds_read_b64_tr_b16 v[52:53], v11 offset:10240
    ds_read_b64_tr_b16 v[54:55], v11 offset:10752
    v_mfma_f32_32x32x16_bf16 v[64:79], v[60:63], v[140:143], v[64:79]
    ds_read_b128 v[152:155], v9 offset:16384
    ds_read_b64_tr_b16 v[56:57], v11 offset:12288
    ds_read_b64_tr_b16 v[58:59], v11 offset:12800
    ds_read_b128 v[156:159], v10 offset:16384
    ds_read_b64_tr_b16 v[60:61], v11 offset:14336
    ds_read_b64_tr_b16 v[62:63], v11 offset:14848
    s_mul_i32 s65, s39, 42
    s_add_u32 m0, s60, -896
    s_add_u32 s65, s65, s59
    buffer_load_dwordx4 v6, s[12:15], s65 offen offset:896 lds
    s_lshr_b32 s64, s39, 5
    s_add_u32 m0, s61, 57344
    s_add_u32 s64, s64, s58
    buffer_load_dwordx4 v2, s[8:11], s64 offen lds
    buffer_load_dwordx4 v3, s[8:11], s64 offen offset:1024 lds
    s_or_b32 s98, s98, s57
    s_xor_b32 s47, s57, 536870912
    s_lshl_b32 s69, s34, 17
    s_add_u32 s69, s69, 6291456
    s_lshl_b32 s48, s33, 12
    s_add_u32 s100, s48, s69
    v_bfe_u32 v26, v1, 3, 2
    v_lshlrev_b32 v26, 15, v26
    v_lshrrev_b32 v44, 5, v1
    v_lshl_add_u32 v26, v44, 11, v26
    v_and_b32 v44, 7, v1
    v_lshl_add_u32 v26, v44, 7, v26
    s_waitcnt lgkmcnt(9)
    v_mfma_f32_32x32x16_bf16 v[64:79], v[48:51], v[144:147], v[64:79]
    s_lshl_b32 s48, s53, 15
    s_add_u32 s35, s100, s48
    s_lshl_b32 s48, s52, 11
    s_add_u32 s35, s35, s48
    s_lshl1_add_u32 s49, s101, s32
    s_lshl_b32 s48, s101, 17
    s_sub_u32 s45, s100, s48
    s_and_b32 s48, s49, 3
    s_waitcnt lgkmcnt(6)
    v_mfma_f32_32x32x16_bf16 v[64:79], v[52:55], v[148:151], v[64:79]
    s_lshl_b32 s48, s48, 15
    s_add_u32 s45, s45, s48
    s_lshr_b32 s48, s49, 2
    s_lshl_b32 s48, s48, 11
    s_add_u32 s45, s45, s48
    s_lshl_b32 s49, s49, 10
    s_lshl_b32 s68, s33, 15
    s_add_u32 s68, s68, 3407872
    s_waitcnt lgkmcnt(0)
    v_mfma_f32_32x32x16_bf16 v[64:79], v[56:59], v[152:155], v[64:79]
    s_waitcnt vmcnt(3)
    s_barrier
    ds_read_b128 v[160:163], v7 offset:32768
    ds_read_b64_tr_b16 v[48:49], v11 offset:16384
    ds_read_b64_tr_b16 v[50:51], v11 offset:16896
    ds_read_b128 v[164:167], v8 offset:32768
    ds_read_b64_tr_b16 v[52:53], v11 offset:18432
    ds_read_b64_tr_b16 v[54:55], v11 offset:18944
    v_mfma_f32_32x32x16_bf16 v[64:79], v[60:63], v[156:159], v[64:79]
    ds_read_b128 v[168:171], v9 offset:32768
    ds_read_b64_tr_b16 v[56:57], v11 offset:20480
    ds_read_b64_tr_b16 v[58:59], v11 offset:20992
    ds_read_b128 v[172:175], v10 offset:32768
    ds_read_b64_tr_b16 v[60:61], v11 offset:22528
    ds_read_b64_tr_b16 v[62:63], v11 offset:23040
    s_mul_i32 s65, s40, 42
    s_add_u32 m0, s60, 7296
    s_add_u32 s65, s65, s59
    buffer_load_dwordx4 v6, s[12:15], s65 offen offset:896 lds
    s_lshr_b32 s64, s40, 5
    s_add_u32 m0, s61, 73728
    s_add_u32 s64, s64, s58
    buffer_load_dwordx4 v2, s[8:11], s64 offen lds
    buffer_load_dwordx4 v3, s[8:11], s64 offen offset:1024 lds
    s_cmp_lt_u32 s32, 6
    s_cbranch_scc1 L_x31
    s_cmp_eq_u32 s32, 6
    s_cbranch_scc1 L_x51
    s_mul_i32 s64, s3, 32
    s_add_u32 s64, s64, 69632
    v_mov_b32 v36, s98
    s_mov_b64 exec, 1
    buffer_store_dword v36, v13, s[20:23], s64 offen sc1
    s_mov_b64 exec, -1
    s_branch L_x31
L_x51:
    buffer_load_dword v28, v26, s[20:23], s100 offen
L_x31:
    s_and_b32 s48, s34, 12
    s_lshl_b32 s48, s48, 11
    s_add_u32 s46, s68, s48
    s_add_u32 s46, s46, s49
    s_add_u32 s68, s68, s5
    v_and_b32 v44, 31, v1
    v_lshrrev_b32 v45, 5, v1
    v_bfe_u32 v46, v1, 1, 3
    s_waitcnt lgkmcnt(9)
    v_mfma_f32_32x32x16_bf16 v[64:79], v[48:51], v[160:163], v[64:79]
    v_xor_b32 v45, v45, v46
    v_mul_u32_u24 v44, 192, v44
    v_lshl_add_u32 v44, v45, 3, v44
    s_mul_i32 s48, s32, 6144
    s_add_u32 s48, s48, 114688
    v_add_u32 v248, s48, v44
    v_xor_b32 v249, 16, v248
    v_xor_b32 v250, 32, v248
    s_waitcnt lgkmcnt(6)
    v_mfma_f32_32x32x16_bf16 v[64:79], v[52:55], v[164:167], v[64:79]
    v_xor_b32 v251, 48, v248
    v_lshrrev_b32 v44, 4, v1
    v_bfe_u32 v45, v1, 2, 2
    v_lshl_add_u32 v44, v44, 3, v45
    v_bfe_u32 v45, v44, 1, 3
    v_and_b32 v46, 3, v1
    v_xor_b32 v45, v45, v46
    v_mul_u32_u24 v44, 192, v44
    s_waitcnt lgkmcnt(0)
    v_mfma_f32_32x32x16_bf16 v[64:79], v[56:59], v[168:171], v[64:79]
    s_waitcnt vmcnt(3)
    s_barrier
    ds_read_b128 v[176:179], v7 offset:0
    ds_read_b64_tr_b16 v[48:49], v11 offset:0
    ds_read_b64_tr_b16 v[50:51], v11 offset:512
    ds_read_b128 v[180:183], v8 offset:0
    ds_read_b64_tr_b16 v[52:53], v11 offset:2048
    ds_read_b64_tr_b16 v[54:55], v11 offset:2560
    v_mfma_f32_32x32x16_bf16 v[64:79], v[60:63], v[172:175], v[64:79]
    ds_read_b128 v[184:187], v9 offset:0
    ds_read_b64_tr_b16 v[56:57], v11 offset:4096
    ds_read_b64_tr_b16 v[58:59], v11 offset:4608
    ds_read_b128 v[188:191], v10 offset:0
    ds_read_b64_tr_b16 v[60:61], v11 offset:6144
    ds_read_b64_tr_b16 v[62:63], v11 offset:6656
    s_mul_i32 s65, s41, 42
    s_add_u32 m0, s60, 15488
    s_add_u32 s65, s65, s59
    buffer_load_dwordx4 v6, s[12:15], s65 offen offset:896 lds
    s_lshr_b32 s64, s41, 5
    s_add_u32 m0, s61, 90112
    s_add_u32 s64, s64, s58
    buffer_load_dwordx4 v2, s[8:11], s64 offen lds
    buffer_load_dwordx4 v3, s[8:11], s64 offen offset:1024 lds
    v_lshl_add_u32 v44, v45, 3, v44
    s_mov_b32 s78, s53
    s_mov_b32 s79, 0
    s_mul_i32 s49, s52, 24576
    s_add_u32 s49, s49, 114688
    v_add_u32 v44, s49, v44
    s_and_b32 s48, s78, 1
    s_lshl_b32 s48, s48, 5
    s_waitcnt lgkmcnt(9)
    v_mfma_f32_32x32x16_bf16 v[64:79], v[48:51], v[176:179], v[64:79]
    v_xor_b32 v45, s48, v44
    s_lshr_b32 s48, s78, 1
    s_lshl_b32 s48, s48, 6
    v_add_u32 v29, s48, v45
    v_xor_b32 v30, 16, v29
    s_lshl_b32 s48, s79, 5
    v_xor_b32 v252, s48, v44
    v_xor_b32 v253, 16, v252
    s_waitcnt lgkmcnt(6)
    v_mfma_f32_32x32x16_bf16 v[64:79], v[52:55], v[180:183], v[64:79]
    v_xor_b32 v254, 32, v252
    v_xor_b32 v255, 48, v252
    v_and_b32 v44, 7, v1
    v_and_b32 v45, 3, v1
    s_and_b32 s48, s34, 12
    v_add_u32 v45, s48, v45
    v_lshlrev_b32 v45, 3, v45
    v_add_u32 v45, s33, v45
    s_waitcnt lgkmcnt(0)
    v_mfma_f32_32x32x16_bf16 v[64:79], v[56:59], v[184:187], v[64:79]
    s_waitcnt vmcnt(3)
    s_barrier
    ds_read_b128 v[192:195], v7 offset:16384
    ds_read_b64_tr_b16 v[48:49], v11 offset:8192
    ds_read_b64_tr_b16 v[50:51], v11 offset:8704
    ds_read_b128 v[196:199], v8 offset:16384
    ds_read_b64_tr_b16 v[52:53], v11 offset:10240
    ds_read_b64_tr_b16 v[54:55], v11 offset:10752
    v_mfma_f32_32x32x16_bf16 v[64:79], v[60:63], v[188:191], v[64:79]
    ds_read_b128 v[200:203], v9 offset:16384
    ds_read_b64_tr_b16 v[56:57], v11 offset:12288
    ds_read_b64_tr_b16 v[58:59], v11 offset:12800
    ds_read_b128 v[204:207], v10 offset:16384
    ds_read_b64_tr_b16 v[60:61], v11 offset:14336
    ds_read_b64_tr_b16 v[62:63], v11 offset:14848
    s_mul_i32 s65, s42, 42
    s_add_u32 m0, s60, -896
    s_add_u32 s65, s65, s59
    buffer_load_dwordx4 v6, s[12:15], s65 offen offset:896 lds
    s_lshr_b32 s64, s42, 5
    s_add_u32 m0, s61, 57344
    s_add_u32 s64, s64, s58
    buffer_load_dwordx4 v2, s[8:11], s64 offen lds
    buffer_load_dwordx4 v3, s[8:11], s64 offen offset:1024 lds
    s_lshl_b32 s48, s34, 3
    v_add_u32 v44, s48, v44
    v_cmp_gt_u32 vcc, 8, v1
    s_mov_b32 s6, 0x3f80
    s_mov_b32 s7, 0x3f800000
    v_cndmask_b32 v44, v45, v44, vcc
    v_mul_u32_u24 v5, 32, v44
    s_cmp_ge_u32 s33, 6
    s_cselect_b32 s48, 1, 0
    s_xor_b32 s4, s33, s48
    s_mul_i32 s55, s33, 14
    s_add_u32 s55, s55, s32
    s_mul_i32 s55, s55, 3584
    v_lshrrev_b32 v44, 4, v1
    v_lshlrev_b32 v45, 2, v44
    v_sub_u32 v45, v1, v45
    s_and_b32 s48, s4, 3
    s_cmp_eq_u32 s48, 3
    s_cselect_b32 s49, 7, 15
    v_and_b32 v45, s49, v45
    v_mul_u32_u24 v44, 896, v44
    v_lshl_add_u32 v44, v45, 4, v44
    s_lshl_b32 s48, s48, 8
    v_add_u32 v17, s48, v44
    s_mov_b32 s48, 155648
    s_cmp_lt_u32 s32, 2
    s_cselect_b32 s43, s48, 63488
    s_add_u32 s43, s43, s5
    s_waitcnt lgkmcnt(9)
    v_mfma_f32_32x32x16_bf16 v[64:79], v[48:51], v[192:195], v[64:79]
    v_lshrrev_b32 v44, 5, v1
    v_bfe_u32 v45, v1, 2, 2
    v_mad_u32_u24 v46, v44, 7, v45
    v_bfe_u32 v44, v1, 4, 1
    v_and_b32 v45, 3, v1
    v_lshl_add_u32 v45, v44, 2, v45
    v_lshlrev_b32 v45, 3, v45
    s_lshl_b32 s48, s53, 6
    s_waitcnt lgkmcnt(6)
    v_mfma_f32_32x32x16_bf16 v[64:79], v[52:55], v[196:199], v[64:79]
    v_add_u32 v47, 0, v46
    v_lshlrev_b32 v44, 6, v47
    v_add3_u32 v44, v44, v45, s48
    v_and_b32 v44, 255, v44
    v_lshl_add_u32 v18, v47, 8, v44
    v_add_u32 v20, 114688, v18
    v_add_u32 v22, 65536, v18
    v_add_u32 v47, 14, v46
    s_waitcnt lgkmcnt(0)
    v_mfma_f32_32x32x16_bf16 v[64:79], v[56:59], v[200:203], v[64:79]
    s_waitcnt vmcnt(3)
    s_barrier
    ds_read_b128 v[208:211], v7 offset:32768
    ds_read_b64_tr_b16 v[48:49], v11 offset:16384
    ds_read_b64_tr_b16 v[50:51], v11 offset:16896
    ds_read_b128 v[212:215], v8 offset:32768
    ds_read_b64_tr_b16 v[52:53], v11 offset:18432
    ds_read_b64_tr_b16 v[54:55], v11 offset:18944
    v_mfma_f32_32x32x16_bf16 v[64:79], v[60:63], v[204:207], v[64:79]
    ds_read_b128 v[216:219], v9 offset:32768
    ds_read_b64_tr_b16 v[56:57], v11 offset:20480
    ds_read_b64_tr_b16 v[58:59], v11 offset:20992
    ds_read_b128 v[220:223], v10 offset:32768
    ds_read_b64_tr_b16 v[60:61], v11 offset:22528
    ds_read_b64_tr_b16 v[62:63], v11 offset:23040
    s_mul_i32 s65, s36, 42
    s_add_u32 m0, s5, 0
    s_add_u32 s65, s65, s59
    s_add_u32 s65, s65, 1792
    buffer_load_dwordx4 v6, s[12:15], s65 offen lds
    s_mul_i32 s65, s37, 42
    s_add_u32 m0, s5, 8192
    s_add_u32 s65, s65, s59
    s_add_u32 s65, s65, 1792
    buffer_load_dwordx4 v6, s[12:15], s65 offen lds
    v_lshlrev_b32 v44, 6, v47
    v_add3_u32 v44, v44, v45, s48
    v_and_b32 v44, 255, v44
    v_lshl_add_u32 v19, v47, 8, v44
    v_add_u32 v21, 114688, v19
    v_add_u32 v23, 65536, v19
    s_mul_i32 s49, s52, 4608
    s_add_u32 s49, s49, 81920
    s_waitcnt lgkmcnt(9)
    v_mfma_f32_32x32x16_bf16 v[64:79], v[48:51], v[208:211], v[64:79]
    v_and_b32 v45, 31, v1
    v_lshrrev_b32 v44, 5, v1
    v_lshlrev_b32 v44, 3, v44
    v_mul_u32_u24 v45, 144, v45
    s_lshl_b32 s48, s78, 5
    s_add_u32 s48, s48, s49
    v_add3_u32 v24, v45, v44, s48
    v_and_b32 v44, 3, v1
    s_waitcnt lgkmcnt(6)
    v_mfma_f32_32x32x16_bf16 v[64:79], v[52:55], v[212:215], v[64:79]
    v_bfe_u32 v45, v1, 3, 1
    v_lshl_add_u32 v44, v45, 2, v44
    v_bfe_u32 v45, v1, 4, 1
    v_bfe_u32 v46, v1, 2, 1
    v_lshl_add_u32 v45, v45, 1, v46
    v_mad_u32_u24 v45, v45, 7, v44
    v_cmp_eq_u32 s[50:51], 7, v44
    v_lshrrev_b32 v46, 5, v1
    s_waitcnt lgkmcnt(0)
    v_mfma_f32_32x32x16_bf16 v[64:79], v[56:59], v[216:219], v[64:79]
    s_waitcnt vmcnt(2)
    s_barrier
    ds_read_b128 v[224:227], v7 offset:0
    ds_read_b64_tr_b16 v[48:49], v11 offset:0
    ds_read_b64_tr_b16 v[50:51], v11 offset:512
    ds_read_b128 v[228:231], v8 offset:0
    ds_read_b64_tr_b16 v[52:53], v11 offset:2048
    ds_read_b64_tr_b16 v[54:55], v11 offset:2560
    v_mfma_f32_32x32x16_bf16 v[64:79], v[60:63], v[220:223], v[64:79]
    ds_read_b128 v[232:235], v9 offset:0
    ds_read_b64_tr_b16 v[56:57], v11 offset:4096
    ds_read_b64_tr_b16 v[58:59], v11 offset:4608
    ds_read_b128 v[236:239], v10 offset:0
    ds_read_b64_tr_b16 v[60:61], v11 offset:6144
    ds_read_b64_tr_b16 v[62:63], v11 offset:6656
    s_mul_i32 s65, s38, 42
    s_add_u32 m0, s5, 16384
    s_add_u32 s65, s65, s59
    s_add_u32 s65, s65, 1792
    buffer_load_dwordx4 v6, s[12:15], s65 offen lds
    s_mul_i32 s65, s39, 42
    s_add_u32 m0, s5, 24576
    s_add_u32 s65, s65, s59
    s_add_u32 s65, s65, 1792
    buffer_load_dwordx4 v6, s[12:15], s65 offen lds
    v_lshlrev_b32 v46, 4, v46
    v_cndmask_b32_e64 v45, v45, 28, s[50:51]
    v_mul_u32_u24 v45, 144, v45
    v_add3_u32 v25, v45, v46, s49
    s_lshl_b32 s49, s52, 15
    v_add_u32 v4, s49, v13
    s_lshl_b32 s48, s53, 10
    s_add_u32 s48, s48, 4096
    s_add_u32 s63, s48, s49
    v_add_u32 v15, s63, v13
    s_lshl_b32 s28, s33, 12
    s_add_u32 s28, s28, s48
    s_lshr_b32 s48, s4, 2
    s_lshl_b32 s48, s48, 16
    s_add_u32 s62, s49, s48
    s_add_u32 s62, s62, s69
    s_and_b32 s48, s53, 1
    s_lshl_b32 s48, s48, 15
    s_lshl_b32 s49, s52, 11
    s_add_u32 s48, s48, s49
    v_add_u32 v27, s48, v13
    s_waitcnt lgkmcnt(9)
    v_mfma_f32_32x32x16_bf16 v[64:79], v[48:51], v[224:227], v[64:79]
    s_waitcnt lgkmcnt(6)
    v_mfma_f32_32x32x16_bf16 v[64:79], v[52:55], v[228:231], v[64:79]
    s_waitcnt lgkmcnt(0)
    v_mfma_f32_32x32x16_bf16 v[64:79], v[56:59], v[232:235], v[64:79]
    s_waitcnt vmcnt(2)
    s_barrier
    v_mfma_f32_32x32x16_bf16 v[64:79], v[60:63], v[236:239], v[64:79]
    s_mul_i32 s65, s40, 42
    s_add_u32 m0, s5, 32768
    s_add_u32 s65, s65, s59
    s_add_u32 s65, s65, 1792
    buffer_load_dwordx4 v6, s[12:15], s65 offen lds
    ds_read_b64_tr_b16 v[48:49], v16 offset:0
    ds_read_b64_tr_b16 v[50:51], v16 offset:512
    ds_read_b64_tr_b16 v[52:53], v16 offset:2048
    ds_read_b64_tr_b16 v[54:55], v16 offset:2560
    ds_read_b64_tr_b16 v[56:57], v16 offset:4096
    ds_read_b64_tr_b16 v[58:59], v16 offset:4608
    s_nop 0
    v_cvt_pk_bf16_f32 v40, v64, v65
    v_cvt_pk_bf16_f32 v41, v66, v67
    v_cvt_pk_bf16_f32 v42, v68, v69
    v_cvt_pk_bf16_f32 v43, v70, v71
    v_cvt_pk_bf16_f32 v44, v72, v73
    v_cvt_pk_bf16_f32 v45, v74, v75
    v_cvt_pk_bf16_f32 v46, v76, v77
    v_cvt_pk_bf16_f32 v47, v78, v79
    v_mfma_f32_32x32x16_bf16 v[112:127], v[240:243], v[40:43], 0
    s_nop 0
    v_mfma_f32_32x32x16_bf16 v[112:127], v[244:247], v[44:47], v[112:127]
    s_waitcnt lgkmcnt(4)
    v_mfma_f32_32x32x16_bf16 v[80:95], v[48:51], v[128:131], 0
    ds_read_b64_tr_b16 v[60:61], v16 offset:6144
    ds_read_b64_tr_b16 v[62:63], v16 offset:6656
    s_mov_b32 s64, 69632
    s_mov_b64 exec, 0xfff
    buffer_load_dword v14, v5, s[20:23], s64 offen sc1
    s_mov_b64 exec, -1
    s_mul_i32 s65, s41, 42
    s_add_u32 m0, s5, 40960
    s_add_u32 s65, s65, s59
    s_add_u32 s65, s65, 1792
    buffer_load_dwordx4 v6, s[12:15], s65 offen lds
    v_max3_f32 v32, v112, v113, v114
    v_max3_f32 v33, -v112, -v113, -v114
    v_max3_f32 v32, v32, v115, v116
    v_max3_f32 v33, v33, -v115, -v116
    v_max3_f32 v32, v32, v117, v118
    v_max3_f32 v33, v33, -v117, -v118
    v_max3_f32 v32, v32, v119, v120
    s_waitcnt lgkmcnt(4)
    v_mfma_f32_32x32x16_bf16 v[80:95], v[52:55], v[132:135], v[80:95]
    ds_read_b64_tr_b16 v[48:49], v16 offset:8192
    ds_read_b64_tr_b16 v[50:51], v16 offset:8704
    v_max3_f32 v33, v33, -v119, -v120
    v_max3_f32 v32, v32, v121, v122
    v_max3_f32 v33, v33, -v121, -v122
    v_max3_f32 v32, v32, v123, v124
    v_max3_f32 v33, v33, -v123, -v124
    v_max3_f32 v32, v32, v125, v126
    s_waitcnt lgkmcnt(4)
    v_mfma_f32_32x32x16_bf16 v[80:95], v[56:59], v[136:139], v[80:95]
    ds_read_b64_tr_b16 v[52:53], v16 offset:10240
    ds_read_b64_tr_b16 v[54:55], v16 offset:10752
    s_mul_i32 s65, s42, 42
    s_add_u32 m0, s5, 49152
    s_add_u32 s65, s65, s59
    s_add_u32 s65, s65, 1792
    buffer_load_dwordx4 v6, s[12:15], s65 offen lds
    v_max3_f32 v33, v33, -v125, -v126
    v_max_f32 v32, v32, v127
    v_max_f32_e64 v33, v33, -v127
    s_nop 1
    v_permlane32_swap_b32 v32, v33
    v_max_f32 v32, v32, v33
    v_mul_f32 v32, s72, v32
    s_waitcnt lgkmcnt(4)
    v_mfma_f32_32x32x16_bf16 v[80:95], v[60:63], v[140:143], v[80:95]
    ds_read_b64_tr_b16 v[56:57], v16 offset:12288
    ds_read_b64_tr_b16 v[58:59], v16 offset:12800
    v_mov_b32 v33, v32
    s_nop 1
    v_permlane32_swap_b32 v32, v33
    v_fma_f32 v64, s72, v112, -v32
    v_fma_f32 v112, -s72, v112, -v33
    v_fma_f32 v65, s72, v113, -v32
    s_waitcnt lgkmcnt(4)
    v_mfma_f32_32x32x16_bf16 v[80:95], v[48:51], v[144:147], v[80:95]
    s_waitcnt vmcnt(4)
    s_barrier
    ds_read_b64_tr_b16 v[60:61], v16 offset:14336
    ds_read_b64_tr_b16 v[62:63], v16 offset:14848
    v_fma_f32 v113, -s72, v113, -v33
    v_fma_f32 v66, s72, v114, -v32
    v_fma_f32 v114, -s72, v114, -v33
    v_fma_f32 v67, s72, v115, -v32
    v_fma_f32 v115, -s72, v115, -v33
    v_fma_f32 v68, s72, v116, -v32
    v_fma_f32 v116, -s72, v116, -v33
    s_waitcnt lgkmcnt(4)
    v_mfma_f32_32x32x16_bf16 v[80:95], v[52:55], v[148:151], v[80:95]
    ds_read_b64_tr_b16 v[48:49], v16 offset:16384
    ds_read_b64_tr_b16 v[50:51], v16 offset:16896
    v_fma_f32 v69, s72, v117, -v32
    v_fma_f32 v117, -s72, v117, -v33
    v_fma_f32 v70, s72, v118, -v32
    v_fma_f32 v118, -s72, v118, -v33
    v_fma_f32 v71, s72, v119, -v32
    v_fma_f32 v119, -s72, v119, -v33
    s_waitcnt lgkmcnt(4)
    v_mfma_f32_32x32x16_bf16 v[80:95], v[56:59], v[152:155], v[80:95]
    ds_read_b64_tr_b16 v[52:53], v16 offset:18432
    ds_read_b64_tr_b16 v[54:55], v16 offset:18944
    s_add_u32 m0, s5, 57344
    s_mul_i32 s65, s36, 42
    s_add_u32 s65, s65, s59
    buffer_load_dwordx4 v6, s[12:15], s65 offen lds
    v_fma_f32 v72, s72, v120, -v32
    v_fma_f32 v120, -s72, v120, -v33
    v_fma_f32 v73, s72, v121, -v32
    v_fma_f32 v121, -s72, v121, -v33
    v_fma_f32 v74, s72, v122, -v32
    v_fma_f32 v122, -s72, v122, -v33
    v_fma_f32 v75, s72, v123, -v32
    s_waitcnt lgkmcnt(4)
    v_mfma_f32_32x32x16_bf16 v[80:95], v[60:63], v[156:159], v[80:95]
    ds_read_b64_tr_b16 v[56:57], v16 offset:20480
    ds_read_b64_tr_b16 v[58:59], v16 offset:20992
    v_fma_f32 v123, -s72, v123, -v33
    v_fma_f32 v76, s72, v124, -v32
    v_fma_f32 v124, -s72, v124, -v33
    v_fma_f32 v77, s72, v125, -v32
    v_fma_f32 v125, -s72, v125, -v33
    v_fma_f32 v78, s72, v126, -v32
    s_waitcnt lgkmcnt(4)
    v_mfma_f32_32x32x16_bf16 v[80:95], v[48:51], v[160:163], v[80:95]
    ds_read_b64_tr_b16 v[60:61], v16 offset:22528
    ds_read_b64_tr_b16 v[62:63], v16 offset:23040
    v_fma_f32 v126, -s72, v126, -v33
    v_fma_f32 v79, s72, v127, -v32
    v_fma_f32 v127, -s72, v127, -v33
    v_exp_f32 v67, v67
    v_exp_f32 v115, v115
    s_waitcnt lgkmcnt(4)
    v_mfma_f32_32x32x16_bf16 v[80:95], v[52:55], v[164:167], v[80:95]
    ds_read_b64_tr_b16 v[48:49], v16 offset:24576
    ds_read_b64_tr_b16 v[50:51], v16 offset:25088
    s_add_u32 m0, s5, 65536
    s_mul_i32 s65, s37, 42
    s_add_u32 s65, s65, s59
    buffer_load_dwordx4 v6, s[12:15], s65 offen lds
    v_exp_f32 v71, v71
    v_exp_f32 v119, v119
    v_exp_f32 v75, v75
    s_waitcnt lgkmcnt(4)
    v_mfma_f32_32x32x16_bf16 v[80:95], v[56:59], v[168:171], v[80:95]
    ds_read_b64_tr_b16 v[52:53], v16 offset:26624
    ds_read_b64_tr_b16 v[54:55], v16 offset:27136
    v_exp_f32 v123, v123
    v_exp_f32 v79, v79
    v_exp_f32 v127, v127
    v_exp_f32 v64, v64
    s_waitcnt lgkmcnt(4)
    v_mfma_f32_32x32x16_bf16 v[80:95], v[60:63], v[172:175], v[80:95]
    ds_read_b64_tr_b16 v[56:57], v16 offset:28672
    ds_read_b64_tr_b16 v[58:59], v16 offset:29184
    v_exp_f32 v112, v112
    v_exp_f32 v65, v65
    v_exp_f32 v113, v113
    s_waitcnt lgkmcnt(4)
    v_mfma_f32_32x32x16_bf16 v[80:95], v[48:51], v[176:179], v[80:95]
    s_waitcnt vmcnt(3)
    s_barrier
    ds_read_b64_tr_b16 v[60:61], v16 offset:30720
    ds_read_b64_tr_b16 v[62:63], v16 offset:31232
    s_add_u32 m0, s5, 73728
    s_mul_i32 s65, s38, 42
    s_add_u32 s65, s65, s59
    buffer_load_dwordx4 v6, s[12:15], s65 offen lds
    v_exp_f32 v66, v66
    v_exp_f32 v114, v114
    v_exp_f32 v68, v68
    s_waitcnt lgkmcnt(4)
    v_mfma_f32_32x32x16_bf16 v[80:95], v[52:55], v[180:183], v[80:95]
    ds_read_b64_tr_b16 v[48:49], v16 offset:32768
    ds_read_b64_tr_b16 v[50:51], v16 offset:33280
    v_exp_f32 v116, v116
    v_exp_f32 v69, v69
    v_exp_f32 v117, v117
    s_waitcnt lgkmcnt(4)
    v_mfma_f32_32x32x16_bf16 v[80:95], v[56:59], v[184:187], v[80:95]
    ds_read_b64_tr_b16 v[52:53], v16 offset:34816
    ds_read_b64_tr_b16 v[54:55], v16 offset:35328
    v_exp_f32 v70, v70
    v_exp_f32 v118, v118
    v_exp_f32 v72, v72
    v_exp_f32 v120, v120
    s_waitcnt lgkmcnt(4)
    v_mfma_f32_32x32x16_bf16 v[80:95], v[60:63], v[188:191], v[80:95]
    ds_read_b64_tr_b16 v[56:57], v16 offset:36864
    ds_read_b64_tr_b16 v[58:59], v16 offset:37376
    s_add_u32 m0, s5, 81920
    s_mul_i32 s65, s39, 42
    s_add_u32 s65, s65, s59
    buffer_load_dwordx4 v6, s[12:15], s65 offen lds
    v_exp_f32 v73, v73
    v_exp_f32 v121, v121
    v_exp_f32 v74, v74
    s_waitcnt lgkmcnt(4)
    v_mfma_f32_32x32x16_bf16 v[80:95], v[48:51], v[192:195], v[80:95]
    ds_read_b64_tr_b16 v[60:61], v16 offset:38912
    ds_read_b64_tr_b16 v[62:63], v16 offset:39424
    v_exp_f32 v122, v122
    v_exp_f32 v76, v76
    v_exp_f32 v124, v124
    s_waitcnt lgkmcnt(4)
    v_mfma_f32_32x32x16_bf16 v[80:95], v[52:55], v[196:199], v[80:95]
    ds_read_b64_tr_b16 v[48:49], v16 offset:40960
    ds_read_b64_tr_b16 v[50:51], v16 offset:41472
    v_exp_f32 v77, v77
    v_exp_f32 v125, v125
    v_exp_f32 v78, v78
    s_waitcnt lgkmcnt(4)
    v_mfma_f32_32x32x16_bf16 v[80:95], v[56:59], v[200:203], v[80:95]
    ds_read_b64_tr_b16 v[52:53], v16 offset:43008
    ds_read_b64_tr_b16 v[54:55], v16 offset:43520
    s_add_u32 m0, s5, 90112
    s_mul_i32 s65, s40, 42
    s_add_u32 s65, s65, s59
    buffer_load_dwordx4 v6, s[12:15], s65 offen lds
    v_exp_f32 v126, v126
    v_add_f32 v34, v67, v71
    v_add_f32 v35, v115, v119
    v_add_f32 v32, v64, v65
    v_add_f32 v33, v112, v113
    v_add_f32 v34, v34, v75
    s_waitcnt lgkmcnt(4)
    v_mfma_f32_32x32x16_bf16 v[80:95], v[60:63], v[204:207], v[80:95]
    ds_read_b64_tr_b16 v[56:57], v16 offset:45056
    ds_read_b64_tr_b16 v[58:59], v16 offset:45568
    v_add_f32 v35, v35, v123
    v_add_f32 v32, v32, v66
    v_add_f32 v33, v33, v114
    v_add_f32 v34, v34, v79
    v_add_f32 v35, v35, v127
    v_add_f32 v32, v32, v68
    s_waitcnt lgkmcnt(4)
    v_mfma_f32_32x32x16_bf16 v[80:95], v[48:51], v[208:211], v[80:95]
    s_waitcnt vmcnt(5)
    s_barrier
    ds_read_b64_tr_b16 v[60:61], v16 offset:47104
    ds_read_b64_tr_b16 v[62:63], v16 offset:47616
    v_add_f32 v33, v33, v116
    v_cndmask_b32 v34, v34, 0, s[70:71]
    v_cndmask_b32 v35, v35, 0, s[70:71]
    v_add_f32 v32, v32, v69
    v_add_f32 v33, v33, v117
    v_add_f32 v34, v34, v70
    v_add_f32 v35, v35, v118
    s_waitcnt lgkmcnt(4)
    v_mfma_f32_32x32x16_bf16 v[80:95], v[52:55], v[212:215], v[80:95]
    ds_read_b64_tr_b16 v[48:49], v16 offset:49152
    ds_read_b64_tr_b16 v[50:51], v16 offset:49664
    s_add_u32 m0, s5, 98304
    s_mul_i32 s65, s41, 42
    s_add_u32 s65, s65, s59
    buffer_load_dwordx4 v6, s[12:15], s65 offen lds
    v_add_f32 v32, v32, v72
    v_add_f32 v33, v33, v120
    v_add_f32 v34, v34, v73
    v_add_f32 v35, v35, v121
    v_add_f32 v32, v32, v74
    v_add_f32 v33, v33, v122
    s_waitcnt lgkmcnt(4)
    v_mfma_f32_32x32x16_bf16 v[80:95], v[56:59], v[216:219], v[80:95]
    ds_read_b64_tr_b16 v[52:53], v16 offset:51200
    ds_read_b64_tr_b16 v[54:55], v16 offset:51712
    v_add_f32 v34, v34, v76
    v_add_f32 v35, v35, v124
    v_add_f32 v32, v32, v77
    v_add_f32 v33, v33, v125
    v_add_f32 v34, v34, v78
    v_add_f32 v35, v35, v126
    v_add_f32 v32, v32, v34
    s_waitcnt lgkmcnt(4)
    v_mfma_f32_32x32x16_bf16 v[80:95], v[60:63], v[220:223], v[80:95]
    ds_read_b64_tr_b16 v[56:57], v16 offset:53248
    ds_read_b64_tr_b16 v[58:59], v16 offset:53760
    v_add_f32 v33, v33, v35
    s_nop 1
    v_permlane32_swap_b32 v32, v33
    v_add_f32 v32, v32, v33
    v_rcp_f32 v32, v32
    s_waitcnt lgkmcnt(4)
    v_mfma_f32_32x32x16_bf16 v[80:95], v[48:51], v[224:227], v[80:95]
    ds_read_b64_tr_b16 v[60:61], v16 offset:55296
    ds_read_b64_tr_b16 v[62:63], v16 offset:55808
    s_add_u32 m0, s5, 106496
    s_mul_i32 s65, s42, 42
    s_add_u32 s65, s65, s59
    buffer_load_dwordx4 v6, s[12:15], s65 offen lds
    v_mov_b32 v33, v32
    s_nop 1
    v_permlane32_swap_b32 v32, v33
    v_mul_f32 v64, v32, v64
    v_mul_f32 v65, v32, v65
    v_mul_f32 v66, v32, v66
    v_mul_f32 v67, v32, v67
    s_waitcnt lgkmcnt(4)
    v_mfma_f32_32x32x16_bf16 v[80:95], v[52:55], v[228:231], v[80:95]
    v_cvt_pk_bf16_f32 v40, v64, v65
    v_cvt_pk_bf16_f32 v41, v66, v67
    ds_write_b64 v248, v[40:41] offset:0
    v_mul_f32 v68, v32, v68
    v_mul_f32 v69, v32, v69
    v_mul_f32 v70, v32, v70
    v_mul_f32 v71, v32, v71
    s_waitcnt lgkmcnt(3)
    v_mfma_f32_32x32x16_bf16 v[80:95], v[56:59], v[232:235], v[80:95]
    s_cmp_lg_u32 s32, 6
    s_cbranch_scc1 L_x21
    buffer_load_dword v7, v26, s[20:23], s100 offen offset:1024
L_x21:
    s_and_b32 s64, s32, 6
    s_cmp_lg_u32 s64, 4
    s_cbranch_scc1 L_wt1
    v_and_b32 v2, 127, v0
    v_min_u32 v2, 97, v2
    v_lshlrev_b32 v2, 7, v2
    s_mul_i32 s64, s75, 12544
    buffer_load_dword v7, v2, s[16:19], s64 offen
L_wt1:
    v_cvt_pk_bf16_f32 v42, v68, v69
    v_cvt_pk_bf16_f32 v43, v70, v71
    ds_write_b64 v249, v[42:43] offset:0
    v_mul_f32 v72, v32, v72
    v_mul_f32 v73, v32, v73
    v_mul_f32 v74, v32, v74
    v_mul_f32 v75, v32, v75
    v_cvt_pk_bf16_f32 v44, v72, v73
    s_waitcnt lgkmcnt(2)
    v_mfma_f32_32x32x16_bf16 v[80:95], v[60:63], v[236:239], v[80:95]
    v_cvt_pk_bf16_f32 v45, v74, v75
    ds_write_b64 v250, v[44:45] offset:0
    v_mul_f32 v76, v32, v76
    v_mul_f32 v77, v32, v77
    v_mul_f32 v78, v32, v78
    v_mul_f32 v79, v32, v79
    v_cvt_pk_bf16_f32 v46, v76, v77
    v_cvt_pk_bf16_f32 v47, v78, v79
    ds_write_b64 v251, v[46:47] offset:0
    v_mul_f32 v112, v33, v112
    v_mul_f32 v113, v33, v113
    v_mul_f32 v114, v33, v114
    v_mul_f32 v115, v33, v115
    v_cvt_pk_bf16_f32 v64, v112, v113
    v_cvt_pk_bf16_f32 v65, v114, v115
    ds_write_b64 v248, v[64:65] offset:64
    v_mul_f32 v116, v33, v116
    v_mul_f32 v117, v33, v117
    v_mul_f32 v118, v33, v118
    v_mul_f32 v119, v33, v119
    v_cvt_pk_bf16_f32 v66, v116, v117
    v_cvt_pk_bf16_f32 v67, v118, v119
    ds_write_b64 v249, v[66:67] offset:64
    v_mul_f32 v120, v33, v120
    v_mul_f32 v121, v33, v121
    v_mul_f32 v122, v33, v122
    v_mul_f32 v123, v33, v123
    v_cvt_pk_bf16_f32 v68, v120, v121
    v_cvt_pk_bf16_f32 v69, v122, v123
    ds_write_b64 v250, v[68:69] offset:64
    v_mul_f32 v124, v33, v124
    v_mul_f32 v125, v33, v125
    v_mul_f32 v126, v33, v126
    v_mul_f32 v127, v33, v127
    v_cvt_pk_bf16_f32 v70, v124, v125
    v_cvt_pk_bf16_f32 v71, v126, v127
    ds_write_b64 v251, v[70:71] offset:64
    v_cndmask_b32 v92, v92, 1.0, s[70:71]
    v_cvt_pk_bf16_f32 v48, v80, v81
    v_cvt_pk_bf16_f32 v49, v82, v83
    ds_write_b64 v248, v[48:49] offset:128
    v_cvt_pk_bf16_f32 v50, v84, v85
    v_cvt_pk_bf16_f32 v51, v86, v87
    ds_write_b64 v249, v[50:51] offset:128
    v_cvt_pk_bf16_f32 v52, v88, v89
    v_cvt_pk_bf16_f32 v53, v90, v91
    ds_write_b64 v250, v[52:53] offset:128
    v_cvt_pk_bf16_f32 v54, v92, v93
    v_cvt_pk_bf16_f32 v55, v94, v95
    ds_write_b64 v251, v[54:55] offset:128
    v_mov_b32 v34, s47
    s_mov_b64 exec, 0xfff
    v_cmp_ne_u32 vcc, s98, v14
    s_mov_b64 exec, -1
    s_mov_b32 s64, s35
    s_and_b32 s65, vcc_lo, 0xff
    s_cselect_b32 s99, 0, 1
    s_and_b32 s65, vcc_lo, 0xf00
    s_cselect_b32 s54, 0, 1
    s_waitcnt lgkmcnt(0)
    s_barrier
    ds_read_b64_tr_b16 v[64:65], v29 offset:0
    ds_read_b64_tr_b16 v[66:67], v30 offset:768
    ds_read_b64_tr_b16 v[68:69], v252 offset:128
    ds_read_b64_tr_b16 v[70:71], v253 offset:896
    ds_read_b64_tr_b16 v[72:73], v254 offset:128
    ds_read_b64_tr_b16 v[74:75], v255 offset:896
    ds_read_b64_tr_b16 v[76:77], v29 offset:6144
    ds_read_b64_tr_b16 v[78:79], v30 offset:6912
    ds_read_b64_tr_b16 v[80:81], v252 offset:6272
    ds_read_b64_tr_b16 v[82:83], v253 offset:7040
    ds_read_b64_tr_b16 v[84:85], v254 offset:6272
    ds_read_b64_tr_b16 v[86:87], v255 offset:7040
    s_mul_i32 s66, s36, 7
    s_lshl1_add_u32 m0, s36, s5
    s_add_u32 s66, s66, s55
    s_sub_u32 s67, s66, 401408
    s_min_u32 s66, s66, s67
    buffer_load_dwordx4 v17, s[16:19], s66 offen lds
    s_mul_i32 s66, s37, 7
    s_lshl1_add_u32 m0, s37, s5
    s_add_u32 s66, s66, s55
    s_sub_u32 s67, s66, 401408
    s_min_u32 s66, s66, s67
    buffer_load_dwordx4 v17, s[16:19], s66 offen lds
    s_waitcnt lgkmcnt(8)
    v_mfma_f32_16x16x32_bf16 v[120:123], v[64:67], v[68:71], 0
    s_waitcnt lgkmcnt(6)
    v_mfma_f32_16x16x32_bf16 v[124:127], v[64:67], v[72:75], 0
    ds_read_b64_tr_b16 v[64:65], v29 offset:12288
    ds_read_b64_tr_b16 v[66:67], v30 offset:13056
    ds_read_b64_tr_b16 v[68:69], v252 offset:12416
    ds_read_b64_tr_b16 v[70:71], v253 offset:13184
    ds_read_b64_tr_b16 v[72:73], v254 offset:12416
    ds_read_b64_tr_b16 v[74:75], v255 offset:13184
    s_waitcnt lgkmcnt(8)
    v_mfma_f32_16x16x32_bf16 v[120:123], v[76:79], v[80:83], v[120:123]
    s_waitcnt lgkmcnt(6)
    v_mfma_f32_16x16x32_bf16 v[124:127], v[76:79], v[84:87], v[124:127]
    ds_read_b64_tr_b16 v[76:77], v29 offset:18432
    ds_read_b64_tr_b16 v[78:79], v30 offset:19200
    ds_read_b64_tr_b16 v[80:81], v252 offset:18560
    ds_read_b64_tr_b16 v[82:83], v253 offset:19328
    ds_read_b64_tr_b16 v[84:85], v254 offset:18560
    ds_read_b64_tr_b16 v[86:87], v255 offset:19328
    s_waitcnt lgkmcnt(8)
    v_mfma_f32_16x16x32_bf16 v[120:123], v[64:67], v[68:71], v[120:123]
    s_waitcnt lgkmcnt(6)
    v_mfma_f32_16x16x32_bf16 v[124:127], v[64:67], v[72:75], v[124:127]
    s_waitcnt lgkmcnt(2)
    v_mfma_f32_16x16x32_bf16 v[120:123], v[76:79], v[80:83], v[120:123]
    s_waitcnt lgkmcnt(0)
    v_mfma_f32_16x16x32_bf16 v[124:127], v[76:79], v[84:87], v[124:127]
    s_cmp_eq_u32 s54, 1
    s_nop 4
    v_cvt_pk_bf16_f32 v120, v120, v121
    v_cvt_pk_bf16_f32 v121, v122, v123
    v_cvt_pk_bf16_f32 v122, v124, v125
    v_cvt_pk_bf16_f32 v123, v126, v127
    s_nop 0
    v_permlane16_swap_b32 v120, v122
    v_permlane16_swap_b32 v121, v123
    v_and_or_b32 v123, v123, s96, v34
    s_cbranch_scc0 L_p1s1
    buffer_store_dwordx4 v[120:123], v13, s[20:23], s64 offen
L_p1j1:
    s_waitcnt vmcnt(3)
    s_barrier
    ds_read_b64_tr_b16 v[48:49], v12 offset:0
    ds_read_b64_tr_b16 v[50:51], v12 offset:512
    ds_read_b64_tr_b16 v[52:53], v12 offset:2048
    ds_read_b64_tr_b16 v[54:55], v12 offset:2560
    ds_read_b64_tr_b16 v[56:57], v12 offset:4096
    ds_read_b64_tr_b16 v[58:59], v12 offset:4608
    s_waitcnt lgkmcnt(4)
    v_mfma_f32_32x32x16_bf16 v[96:111], v[48:51], v[128:131], 0
    ds_read_b64_tr_b16 v[60:61], v12 offset:6144
    ds_read_b64_tr_b16 v[62:63], v12 offset:6656
    s_waitcnt lgkmcnt(4)
    v_mfma_f32_32x32x16_bf16 v[96:111], v[52:55], v[132:135], v[96:111]
    ds_read_b64_tr_b16 v[48:49], v12 offset:8192
    ds_read_b64_tr_b16 v[50:51], v12 offset:8704
    s_waitcnt lgkmcnt(4)
    v_mfma_f32_32x32x16_bf16 v[96:111], v[56:59], v[136:139], v[96:111]
    ds_read_b64_tr_b16 v[52:53], v12 offset:10240
    ds_read_b64_tr_b16 v[54:55], v12 offset:10752
    s_waitcnt lgkmcnt(4)
    v_mfma_f32_32x32x16_bf16 v[96:111], v[60:63], v[140:143], v[96:111]
    ds_read_b64_tr_b16 v[56:57], v12 offset:12288
    ds_read_b64_tr_b16 v[58:59], v12 offset:12800
    s_waitcnt lgkmcnt(4)
    v_mfma_f32_32x32x16_bf16 v[96:111], v[48:51], v[144:147], v[96:111]
    ds_read_b64_tr_b16 v[60:61], v12 offset:14336
    ds_read_b64_tr_b16 v[62:63], v12 offset:14848
    s_cmp_ge_u32 s32, 2
    s_cbranch_scc1 L_l1a1
    s_add_u32 s64, s45, 0
    buffer_load_dwordx4 v[64:67], v13, s[20:23], s64 offen sc1
    s_add_u32 s64, s45, 131072
    buffer_load_dwordx4 v[68:71], v13, s[20:23], s64 offen sc1
    s_add_u32 s64, s45, 262144
    buffer_load_dwordx4 v[72:75], v13, s[20:23], s64 offen sc1
    s_add_u32 s64, s45, 393216
    buffer_load_dwordx4 v[76:79], v13, s[20:23], s64 offen sc1
L_l1a1:
    s_waitcnt lgkmcnt(4)
    v_mfma_f32_32x32x16_bf16 v[96:111], v[52:55], v[148:151], v[96:111]
    ds_read_b64_tr_b16 v[48:49], v12 offset:16384
    ds_read_b64_tr_b16 v[50:51], v12 offset:16896
    s_waitcnt lgkmcnt(4)
    v_mfma_f32_32x32x16_bf16 v[96:111], v[56:59], v[152:155], v[96:111]
    ds_read_b64_tr_b16 v[52:53], v12 offset:18432
    ds_read_b64_tr_b16 v[54:55], v12 offset:18944
    s_waitcnt lgkmcnt(4)
    v_mfma_f32_32x32x16_bf16 v[96:111], v[60:63], v[156:159], v[96:111]
    ds_read_b64_tr_b16 v[56:57], v12 offset:20480
    ds_read_b64_tr_b16 v[58:59], v12 offset:20992
    s_cmp_ge_u32 s32, 2
    s_cbranch_scc1 L_l1b1
    v_mov_b32 v35, 0xffff0000
    s_mov_b32 s73, 0
L_g11:
    s_waitcnt vmcnt(3)
    v_lshlrev_b32 v80, 16, v64
    v_and_b32 v81, v35, v64
    v_lshlrev_b32 v82, 16, v65
    v_and_b32 v83, v35, v65
    v_lshlrev_b32 v84, 16, v66
    v_and_b32 v85, v35, v66
    v_lshlrev_b32 v86, 16, v67
    v_xor_b32 v40, s47, v67
    s_waitcnt vmcnt(2)
    v_lshlrev_b32 v88, 16, v68
    v_and_b32 v89, v35, v68
    v_lshlrev_b32 v90, 16, v69
    v_and_b32 v91, v35, v69
    v_lshlrev_b32 v92, 16, v70
    v_and_b32 v93, v35, v70
    v_lshlrev_b32 v94, 16, v71
    v_add_f32 v80, v80, v88
    v_add_f32 v81, v81, v89
    v_add_f32 v82, v82, v90
    v_add_f32 v83, v83, v91
    v_add_f32 v84, v84, v92
    v_add_f32 v85, v85, v93
    v_add_f32 v86, v86, v94
    v_bitop3_b32 v40, v40, s47, v71 bitop3:0xf6
    s_waitcnt vmcnt(1)
    v_lshlrev_b32 v88, 16, v72
    v_and_b32 v89, v35, v72
    v_lshlrev_b32 v90, 16, v73
    v_and_b32 v91, v35, v73
    v_lshlrev_b32 v92, 16, v74
    v_and_b32 v93, v35, v74
    v_lshlrev_b32 v94, 16, v75
    v_add_f32 v80, v80, v88
    v_add_f32 v81, v81, v89
    v_add_f32 v82, v82, v90
    v_add_f32 v83, v83, v91
    v_add_f32 v84, v84, v92
    v_add_f32 v85, v85, v93
    v_add_f32 v86, v86, v94
    v_bitop3_b32 v40, v40, s47, v75 bitop3:0xf6
    s_waitcnt vmcnt(0)
    v_lshlrev_b32 v88, 16, v76
    v_and_b32 v89, v35, v76
    v_lshlrev_b32 v90, 16, v77
    v_and_b32 v91, v35, v77
    v_lshlrev_b32 v92, 16, v78
    v_and_b32 v93, v35, v78
    v_lshlrev_b32 v94, 16, v79
    v_add_f32 v80, v80, v88
    v_add_f32 v81, v81, v89
    v_add_f32 v82, v82, v90
    v_add_f32 v83, v83, v91
    v_add_f32 v84, v84, v92
    v_add_f32 v85, v85, v93
    v_add_f32 v86, v86, v94
    v_bitop3_b32 v40, v40, s47, v79 bitop3:0xf6
    v_cmp_lt_u32 vcc, s96, v40
    s_cbranch_vccz L_g11x
    s_add_u32 s73, s73, 1
    s_cmp_ge_u32 s73, 100000
    s_cbranch_scc1 L_g11x
    s_add_u32 s64, s45, 0
    buffer_load_dwordx4 v[64:67], v13, s[20:23], s64 offen sc1
    s_add_u32 s64, s45, 131072
    buffer_load_dwordx4 v[68:71], v13, s[20:23], s64 offen sc1
    s_add_u32 s64, s45, 262144
    buffer_load_dwordx4 v[72:75], v13, s[20:23], s64 offen sc1
    s_add_u32 s64, s45, 393216
    buffer_load_dwordx4 v[76:79], v13, s[20:23], s64 offen sc1
    s_waitcnt vmcnt(0)
    s_branch L_g11
L_g11x:
    v_mov_b32 v34, s57
    v_cvt_pk_bf16_f32 v112, v80, v81
    v_cvt_pk_bf16_f32 v113, v82, v83
    v_cvt_pk_bf16_f32 v114, v84, v85
    v_cvt_pk_bf16_f32 v115, v86, v86
    v_and_or_b32 v115, v115, s96, v34
    buffer_store_dwordx4 v[112:115], v13, s[20:23], s46 offen sc1
L_l1b1:
    s_waitcnt lgkmcnt(4)
    v_mfma_f32_32x32x16_bf16 v[96:111], v[48:51], v[160:163], v[96:111]
    ds_read_b64_tr_b16 v[60:61], v12 offset:22528
    ds_read_b64_tr_b16 v[62:63], v12 offset:23040
    s_waitcnt lgkmcnt(4)
    v_mfma_f32_32x32x16_bf16 v[96:111], v[52:55], v[164:167], v[96:111]
    ds_read_b64_tr_b16 v[48:49], v12 offset:24576
    ds_read_b64_tr_b16 v[50:51], v12 offset:25088
    s_mul_i32 s66, s38, 7
    s_lshl1_add_u32 m0, s38, s5
    s_add_u32 s66, s66, s55
    s_sub_u32 s67, s66, 401408
    s_min_u32 s66, s66, s67
    buffer_load_dwordx4 v17, s[16:19], s66 offen lds
    s_waitcnt lgkmcnt(4)
    v_mfma_f32_32x32x16_bf16 v[96:111], v[56:59], v[168:171], v[96:111]
    ds_read_b64_tr_b16 v[52:53], v12 offset:26624
    ds_read_b64_tr_b16 v[54:55], v12 offset:27136
    s_waitcnt lgkmcnt(4)
    v_mfma_f32_32x32x16_bf16 v[96:111], v[60:63], v[172:175], v[96:111]
    ds_read_b64_tr_b16 v[56:57], v12 offset:28672
    ds_read_b64_tr_b16 v[58:59], v12 offset:29184
    s_mul_i32 s66, s39, 7
    s_lshl1_add_u32 m0, s39, s5
    s_add_u32 s66, s66, s55
    s_sub_u32 s67, s66, 401408
    s_min_u32 s66, s66, s67
    buffer_load_dwordx4 v17, s[16:19], s66 offen lds
    s_waitcnt lgkmcnt(4)
    v_mfma_f32_32x32x16_bf16 v[96:111], v[48:51], v[176:179], v[96:111]
    ds_read_b64_tr_b16 v[60:61], v12 offset:30720
    ds_read_b64_tr_b16 v[62:63], v12 offset:31232
    s_waitcnt lgkmcnt(4)
    v_mfma_f32_32x32x16_bf16 v[96:111], v[52:55], v[180:183], v[96:111]
    ds_read_b64_tr_b16 v[48:49], v12 offset:32768
    ds_read_b64_tr_b16 v[50:51], v12 offset:33280
    s_mul_i32 s66, s40, 7
    s_lshl1_add_u32 m0, s40, s5
    s_add_u32 s66, s66, s55
    s_sub_u32 s67, s66, 401408
    s_min_u32 s66, s66, s67
    buffer_load_dwordx4 v17, s[16:19], s66 offen lds
    s_waitcnt lgkmcnt(4)
    v_mfma_f32_32x32x16_bf16 v[96:111], v[56:59], v[184:187], v[96:111]
    ds_read_b64_tr_b16 v[52:53], v12 offset:34816
    ds_read_b64_tr_b16 v[54:55], v12 offset:35328
    s_waitcnt lgkmcnt(4)
    v_mfma_f32_32x32x16_bf16 v[96:111], v[60:63], v[188:191], v[96:111]
    ds_read_b64_tr_b16 v[56:57], v12 offset:36864
    ds_read_b64_tr_b16 v[58:59], v12 offset:37376
    s_mul_i32 s66, s41, 7
    s_lshl1_add_u32 m0, s41, s5
    s_add_u32 s66, s66, s55
    s_sub_u32 s67, s66, 401408
    s_min_u32 s66, s66, s67
    buffer_load_dwordx4 v17, s[16:19], s66 offen lds
    s_waitcnt lgkmcnt(4)
    v_mfma_f32_32x32x16_bf16 v[96:111], v[48:51], v[192:195], v[96:111]
    ds_read_b64_tr_b16 v[60:61], v12 offset:38912
    ds_read_b64_tr_b16 v[62:63], v12 offset:39424
    s_waitcnt lgkmcnt(4)
    v_mfma_f32_32x32x16_bf16 v[96:111], v[52:55], v[196:199], v[96:111]
    ds_read_b64_tr_b16 v[48:49], v12 offset:40960
    ds_read_b64_tr_b16 v[50:51], v12 offset:41472
    s_mul_i32 s66, s42, 7
    s_lshl1_add_u32 m0, s42, s5
    s_add_u32 s66, s66, s55
    s_sub_u32 s67, s66, 401408
    s_min_u32 s66, s66, s67
    buffer_load_dwordx4 v17, s[16:19], s66 offen lds
    s_waitcnt lgkmcnt(4)
    v_mfma_f32_32x32x16_bf16 v[96:111], v[56:59], v[200:203], v[96:111]
    ds_read_b64_tr_b16 v[52:53], v12 offset:43008
    ds_read_b64_tr_b16 v[54:55], v12 offset:43520
    s_waitcnt lgkmcnt(4)
    v_mfma_f32_32x32x16_bf16 v[96:111], v[60:63], v[204:207], v[96:111]
    ds_read_b64_tr_b16 v[56:57], v12 offset:45056
    ds_read_b64_tr_b16 v[58:59], v12 offset:45568
    s_waitcnt lgkmcnt(4)
    v_mfma_f32_32x32x16_bf16 v[96:111], v[48:51], v[208:211], v[96:111]
    ds_read_b64_tr_b16 v[60:61], v12 offset:47104
    ds_read_b64_tr_b16 v[62:63], v12 offset:47616
    s_waitcnt lgkmcnt(4)
    v_mfma_f32_32x32x16_bf16 v[96:111], v[52:55], v[212:215], v[96:111]
    ds_read_b64_tr_b16 v[48:49], v12 offset:49152
    ds_read_b64_tr_b16 v[50:51], v12 offset:49664
    s_add_u32 m0, s5, 114688
    s_add_u32 s66, s55, 200704
    s_sub_u32 s67, s66, 401408
    s_min_u32 s66, s66, s67
    buffer_load_dwordx4 v17, s[16:19], s66 offen lds
    s_waitcnt lgkmcnt(4)
    v_mfma_f32_32x32x16_bf16 v[96:111], v[56:59], v[216:219], v[96:111]
    ds_read_b64_tr_b16 v[52:53], v12 offset:51200
    ds_read_b64_tr_b16 v[54:55], v12 offset:51712
    s_waitcnt lgkmcnt(4)
    v_mfma_f32_32x32x16_bf16 v[96:111], v[60:63], v[220:223], v[96:111]
    ds_read_b64_tr_b16 v[56:57], v12 offset:53248
    ds_read_b64_tr_b16 v[58:59], v12 offset:53760
    s_waitcnt lgkmcnt(4)
    v_mfma_f32_32x32x16_bf16 v[96:111], v[48:51], v[224:227], v[96:111]
    ds_read_b64_tr_b16 v[60:61], v12 offset:55296
    ds_read_b64_tr_b16 v[62:63], v12 offset:55808
    s_add_u32 m0, s5, 122880
    s_add_u32 s66, s55, 229376
    s_sub_u32 s67, s66, 401408
    s_min_u32 s66, s66, s67
    buffer_load_dwordx4 v17, s[16:19], s66 offen lds
    s_waitcnt lgkmcnt(4)
    v_mfma_f32_32x32x16_bf16 v[96:111], v[52:55], v[228:231], v[96:111]
    s_waitcnt lgkmcnt(2)
    v_mfma_f32_32x32x16_bf16 v[96:111], v[56:59], v[232:235], v[96:111]
    s_waitcnt lgkmcnt(0)
    v_mfma_f32_32x32x16_bf16 v[96:111], v[60:63], v[236:239], v[96:111]
    s_waitcnt vmcnt(2)
    s_barrier
    ds_read_b64_tr_b16 v[128:129], v18 offset:0
    ds_read_b64_tr_b16 v[130:131], v18 offset:1024
    ds_read_b64_tr_b16 v[132:133], v19 offset:0
    ds_read_b64_tr_b16 v[134:135], v19 offset:1024
    ds_read_b64_tr_b16 v[136:137], v18 offset:7168
    ds_read_b64_tr_b16 v[138:139], v18 offset:8192
    ds_read_b64_tr_b16 v[140:141], v19 offset:7168
    ds_read_b64_tr_b16 v[142:143], v19 offset:8192
    ds_read_b64_tr_b16 v[144:145], v18 offset:14336
    ds_read_b64_tr_b16 v[146:147], v18 offset:15360
    ds_read_b64_tr_b16 v[148:149], v19 offset:14336
    ds_read_b64_tr_b16 v[150:151], v19 offset:15360
    v_cvt_pk_bf16_f32 v48, v96, v97
    v_cvt_pk_bf16_f32 v49, v98, v99
    v_cvt_pk_bf16_f32 v50, v100, v101
    v_cvt_pk_bf16_f32 v51, v102, v103
    v_cvt_pk_bf16_f32 v52, v104, v105
    v_cvt_pk_bf16_f32 v53, v106, v107
    v_cvt_pk_bf16_f32 v54, v108, v109
    v_cvt_pk_bf16_f32 v55, v110, v111
    v_mfma_f32_32x32x16_bf16 v[112:127], v[240:243], v[48:51], 0
    s_nop 0
    v_mfma_f32_32x32x16_bf16 v[112:127], v[244:247], v[52:55], v[112:127]
    s_waitcnt lgkmcnt(8)
    ds_read_b64_tr_b16 v[152:153], v18 offset:21504
    ds_read_b64_tr_b16 v[154:155], v18 offset:22528
    ds_read_b64_tr_b16 v[156:157], v19 offset:21504
    ds_read_b64_tr_b16 v[158:159], v19 offset:22528
    s_waitcnt lgkmcnt(8)
    ds_read_b64_tr_b16 v[160:161], v18 offset:28672
    ds_read_b64_tr_b16 v[162:163], v18 offset:29696
    ds_read_b64_tr_b16 v[164:165], v19 offset:28672
    ds_read_b64_tr_b16 v[166:167], v19 offset:29696
    s_nop 1
    v_max3_f32 v32, v112, v113, v114
    v_max3_f32 v33, -v112, -v113, -v114
    v_max3_f32 v32, v32, v115, v116
    v_max3_f32 v33, v33, -v115, -v116
    v_max3_f32 v32, v32, v117, v118
    v_max3_f32 v33, v33, -v117, -v118
    v_max3_f32 v32, v32, v119, v120
    v_max3_f32 v33, v33, -v119, -v120
    v_max3_f32 v32, v32, v121, v122
    v_max3_f32 v33, v33, -v121, -v122
    v_max3_f32 v32, v32, v123, v124
    v_max3_f32 v33, v33, -v123, -v124
    v_max3_f32 v32, v32, v125, v126
    v_max3_f32 v33, v33, -v125, -v126
    v_max_f32 v32, v32, v127
    v_max_f32_e64 v33, v33, -v127
    s_nop 1
    v_permlane32_swap_b32 v32, v33
    v_max_f32 v32, v32, v33
    v_mul_f32 v32, s72, v32
    v_mov_b32 v33, v32
    s_nop 1
    v_permlane32_swap_b32 v32, v33
    v_pk_fma_f32 v[96:97], v[112:113], s[72:73], v[32:33] op_sel_hi:[1,0,0] neg_lo:[0,0,1] neg_hi:[0,0,1]
    v_pk_fma_f32 v[112:113], v[112:113], s[72:73], v[32:33] op_sel:[0,0,1] op_sel_hi:[1,0,1] neg_lo:[1,0,1] neg_hi:[1,0,1]
    v_pk_fma_f32 v[98:99], v[114:115], s[72:73], v[32:33] op_sel_hi:[1,0,0] neg_lo:[0,0,1] neg_hi:[0,0,1]
    s_add_u32 s64, s68, 0
    buffer_load_dwordx4 v[64:67], v13, s[20:23], s64 offen sc1
    s_add_u32 s64, s68, 8192
    buffer_load_dwordx4 v[68:71], v13, s[20:23], s64 offen sc1
    v_pk_fma_f32 v[114:115], v[114:115], s[72:73], v[32:33] op_sel:[0,0,1] op_sel_hi:[1,0,1] neg_lo:[1,0,1] neg_hi:[1,0,1]
    v_pk_fma_f32 v[100:101], v[116:117], s[72:73], v[32:33] op_sel_hi:[1,0,0] neg_lo:[0,0,1] neg_hi:[0,0,1]
    v_pk_fma_f32 v[116:117], v[116:117], s[72:73], v[32:33] op_sel:[0,0,1] op_sel_hi:[1,0,1] neg_lo:[1,0,1] neg_hi:[1,0,1]
    v_pk_fma_f32 v[102:103], v[118:119], s[72:73], v[32:33] op_sel_hi:[1,0,0] neg_lo:[0,0,1] neg_hi:[0,0,1]
    v_pk_fma_f32 v[118:119], v[118:119], s[72:73], v[32:33] op_sel:[0,0,1] op_sel_hi:[1,0,1] neg_lo:[1,0,1] neg_hi:[1,0,1]
    v_pk_fma_f32 v[104:105], v[120:121], s[72:73], v[32:33] op_sel_hi:[1,0,0] neg_lo:[0,0,1] neg_hi:[0,0,1]
    v_pk_fma_f32 v[120:121], v[120:121], s[72:73], v[32:33] op_sel:[0,0,1] op_sel_hi:[1,0,1] neg_lo:[1,0,1] neg_hi:[1,0,1]
    v_pk_fma_f32 v[106:107], v[122:123], s[72:73], v[32:33] op_sel_hi:[1,0,0] neg_lo:[0,0,1] neg_hi:[0,0,1]
    v_pk_fma_f32 v[122:123], v[122:123], s[72:73], v[32:33] op_sel:[0,0,1] op_sel_hi:[1,0,1] neg_lo:[1,0,1] neg_hi:[1,0,1]
    v_pk_fma_f32 v[108:109], v[124:125], s[72:73], v[32:33] op_sel_hi:[1,0,0] neg_lo:[0,0,1] neg_hi:[0,0,1]
    v_pk_fma_f32 v[124:125], v[124:125], s[72:73], v[32:33] op_sel:[0,0,1] op_sel_hi:[1,0,1] neg_lo:[1,0,1] neg_hi:[1,0,1]
    s_add_u32 s64, s68, 16384
    buffer_load_dwordx4 v[72:75], v13, s[20:23], s64 offen sc1
    s_add_u32 s64, s68, 24576
    buffer_load_dwordx4 v[76:79], v13, s[20:23], s64 offen sc1
    v_pk_fma_f32 v[110:111], v[126:127], s[72:73], v[32:33] op_sel_hi:[1,0,0] neg_lo:[0,0,1] neg_hi:[0,0,1]
    v_pk_fma_f32 v[126:127], v[126:127], s[72:73], v[32:33] op_sel:[0,0,1] op_sel_hi:[1,0,1] neg_lo:[1,0,1] neg_hi:[1,0,1]
    v_exp_f32 v98, v98
    v_exp_f32 v114, v114
    v_exp_f32 v99, v99
    v_exp_f32 v115, v115
    v_exp_f32 v102, v102
    v_exp_f32 v118, v118
    v_exp_f32 v103, v103
    v_exp_f32 v119, v119
    v_exp_f32 v106, v106
    v_exp_f32 v122, v122
    v_exp_f32 v107, v107
    v_exp_f32 v123, v123
    v_exp_f32 v110, v110
    v_exp_f32 v126, v126
    v_exp_f32 v111, v111
    v_exp_f32 v127, v127
    v_exp_f32 v96, v96
    v_exp_f32 v112, v112
    v_exp_f32 v97, v97
    v_exp_f32 v113, v113
    v_exp_f32 v100, v100
    s_add_u32 m0, s5, 131072
    s_add_u32 s66, s55, 258048
    s_sub_u32 s67, s66, 401408
    s_min_u32 s66, s66, s67
    buffer_load_dwordx4 v17, s[16:19], s66 offen lds
    v_exp_f32 v116, v116
    v_exp_f32 v101, v101
    v_exp_f32 v117, v117
    v_exp_f32 v104, v104
    v_exp_f32 v120, v120
    v_exp_f32 v105, v105
    v_exp_f32 v121, v121
    v_exp_f32 v108, v108
    v_exp_f32 v124, v124
    v_exp_f32 v109, v109
    v_exp_f32 v125, v125
    v_pk_add_f32 v[32:33], v[98:99], v[102:103]
    s_waitcnt lgkmcnt(8)
    ds_read_b64_tr_b16 v[168:169], v18 offset:35840
    ds_read_b64_tr_b16 v[170:171], v18 offset:36864
    ds_read_b64_tr_b16 v[172:173], v19 offset:35840
    ds_read_b64_tr_b16 v[174:175], v19 offset:36864
    v_pk_add_f32 v[34:35], v[114:115], v[118:119]
    v_pk_add_f32 v[36:37], v[106:107], v[110:111]
    v_pk_add_f32 v[38:39], v[122:123], v[126:127]
    v_pk_add_f32 v[32:33], v[32:33], v[36:37]
    v_pk_add_f32 v[34:35], v[34:35], v[38:39]
    v_pk_add_f32 v[36:37], v[96:97], v[100:101]
    v_pk_add_f32 v[38:39], v[112:113], v[116:117]
    v_cndmask_b32 v33, v33, 0, s[70:71]
    v_cndmask_b32 v35, v35, 0, s[70:71]
    v_pk_add_f32 v[36:37], v[36:37], v[104:105]
    v_pk_add_f32 v[38:39], v[38:39], v[120:121]
    v_pk_add_f32 v[32:33], v[32:33], v[108:109]
    s_waitcnt lgkmcnt(8)
    ds_read_b64_tr_b16 v[176:177], v18 offset:43008
    ds_read_b64_tr_b16 v[178:179], v18 offset:44032
    ds_read_b64_tr_b16 v[180:181], v19 offset:43008
    ds_read_b64_tr_b16 v[182:183], v19 offset:44032
    s_add_u32 m0, s5, 139264
    s_add_u32 s66, s55, 286720
    s_sub_u32 s67, s66, 401408
    s_min_u32 s66, s66, s67
    buffer_load_dwordx4 v17, s[16:19], s66 offen lds
    v_pk_add_f32 v[34:35], v[34:35], v[124:125]
    v_pk_add_f32 v[32:33], v[32:33], v[36:37]
    v_pk_add_f32 v[34:35], v[34:35], v[38:39]
    v_add_f32 v32, v32, v33
    v_add_f32 v33, v34, v35
    s_nop 1
    v_permlane32_swap_b32 v32, v33
    v_add_f32 v32, v32, v33
    v_mov_b32 v33, v32
    s_nop 1
    v_permlane32_swap_b32 v32, v33
    v_rcp_f32 v33, v33
    v_mul_f32 v31, s74, v32
    s_waitcnt lgkmcnt(8)
    ds_read_b64_tr_b16 v[184:185], v18 offset:50176
    ds_read_b64_tr_b16 v[186:187], v18 offset:51200
    ds_read_b64_tr_b16 v[188:189], v19 offset:50176
    ds_read_b64_tr_b16 v[190:191], v19 offset:51200
    v_cvt_pk_bf16_f32 v48, v96, v97
    v_cvt_pk_bf16_f32 v49, v98, v99
    v_cvt_pk_bf16_f32 v50, v100, v101
    v_cvt_pk_bf16_f32 v51, v102, v103
    v_cvt_pk_bf16_f32 v52, v104, v105
    v_cvt_pk_bf16_f32 v53, v106, v107
    v_cvt_pk_bf16_f32 v54, v108, v109
    v_cvt_pk_bf16_f32 v55, v110, v111
    v_mul_f32 v33, v32, v33
    v_pk_mul_f32 v[112:113], v[112:113], v[32:33] op_sel:[0,1] op_sel_hi:[1,1]
    v_pk_mul_f32 v[114:115], v[114:115], v[32:33] op_sel:[0,1] op_sel_hi:[1,1]
    v_pk_mul_f32 v[116:117], v[116:117], v[32:33] op_sel:[0,1] op_sel_hi:[1,1]
    s_add_u32 m0, s5, 147456
    s_add_u32 s66, s55, 315392
    s_sub_u32 s67, s66, 401408
    s_min_u32 s66, s66, s67
    buffer_load_dwordx4 v17, s[16:19], s66 offen lds
    v_pk_mul_f32 v[118:119], v[118:119], v[32:33] op_sel:[0,1] op_sel_hi:[1,1]
    v_pk_mul_f32 v[120:121], v[120:121], v[32:33] op_sel:[0,1] op_sel_hi:[1,1]
    v_pk_mul_f32 v[122:123], v[122:123], v[32:33] op_sel:[0,1] op_sel_hi:[1,1]
    v_pk_mul_f32 v[124:125], v[124:125], v[32:33] op_sel:[0,1] op_sel_hi:[1,1]
    v_pk_mul_f32 v[126:127], v[126:127], v[32:33] op_sel:[0,1] op_sel_hi:[1,1]
    v_cvt_pk_bf16_f32 v56, v112, v113
    v_cvt_pk_bf16_f32 v57, v114, v115
    v_cvt_pk_bf16_f32 v58, v116, v117
    v_cvt_pk_bf16_f32 v59, v118, v119
    v_cvt_pk_bf16_f32 v60, v120, v121
    v_cvt_pk_bf16_f32 v61, v122, v123
    v_cvt_pk_bf16_f32 v62, v124, v125
    v_cvt_pk_bf16_f32 v63, v126, v127
    s_mov_b32 s73, 0
L_g21:
    s_waitcnt vmcnt(6)
    v_dot2_f32_bf16 v80, v64, s6, 0
    v_dot2_f32_bf16 v81, v64, s7, 0
    v_dot2_f32_bf16 v82, v65, s6, 0
    v_dot2_f32_bf16 v83, v65, s7, 0
    v_dot2_f32_bf16 v84, v66, s6, 0
    v_dot2_f32_bf16 v85, v66, s7, 0
    v_dot2_f32_bf16 v86, v67, s6, 0
    v_xor_b32 v40, s57, v67
    s_waitcnt vmcnt(5)
    v_dot2_f32_bf16 v80, v68, s6, v80
    v_dot2_f32_bf16 v81, v68, s7, v81
    v_dot2_f32_bf16 v82, v69, s6, v82
    v_dot2_f32_bf16 v83, v69, s7, v83
    v_dot2_f32_bf16 v84, v70, s6, v84
    v_dot2_f32_bf16 v85, v70, s7, v85
    v_dot2_f32_bf16 v86, v71, s6, v86
    v_bitop3_b32 v40, v40, s57, v71 bitop3:0xf6
    s_waitcnt vmcnt(4)
    v_dot2_f32_bf16 v80, v72, s6, v80
    v_dot2_f32_bf16 v81, v72, s7, v81
    v_dot2_f32_bf16 v82, v73, s6, v82
    v_dot2_f32_bf16 v83, v73, s7, v83
    v_dot2_f32_bf16 v84, v74, s6, v84
    v_dot2_f32_bf16 v85, v74, s7, v85
    v_dot2_f32_bf16 v86, v75, s6, v86
    v_bitop3_b32 v40, v40, s57, v75 bitop3:0xf6
    s_waitcnt vmcnt(3)
    v_dot2_f32_bf16 v80, v76, s6, v80
    v_dot2_f32_bf16 v81, v76, s7, v81
    v_dot2_f32_bf16 v82, v77, s6, v82
    v_dot2_f32_bf16 v83, v77, s7, v83
    v_dot2_f32_bf16 v84, v78, s6, v84
    v_dot2_f32_bf16 v85, v78, s7, v85
    v_dot2_f32_bf16 v86, v79, s6, v86
    v_bitop3_b32 v40, v40, s57, v79 bitop3:0xf6
    v_cmp_lt_u32 vcc, s96, v40
    s_cbranch_vccz L_g21x
    s_add_u32 s73, s73, 1
    s_cmp_ge_u32 s73, 100000
    s_cbranch_scc1 L_g21x
    s_add_u32 s64, s68, 0
    buffer_load_dwordx4 v[64:67], v13, s[20:23], s64 offen sc1
    s_add_u32 s64, s68, 8192
    buffer_load_dwordx4 v[68:71], v13, s[20:23], s64 offen sc1
    s_add_u32 s64, s68, 16384
    buffer_load_dwordx4 v[72:75], v13, s[20:23], s64 offen sc1
    s_add_u32 s64, s68, 24576
    buffer_load_dwordx4 v[76:79], v13, s[20:23], s64 offen sc1
    s_waitcnt vmcnt(0)
    s_branch L_g21
L_g21x:
    v_cvt_pk_bf16_f32 v64, v80, v81
    v_cvt_pk_bf16_f32 v65, v82, v83
    v_cvt_pk_bf16_f32 v66, v84, v85
    v_cvt_pk_bf16_f32 v67, v86, 0
    ds_write2_b64 v24, v[64:65], v[66:67] offset0:0 offset1:2
    v_mov_b32 v34, s57
    s_mov_b32 m0, s43
    s_add_u32 s66, s55, 344064
    s_sub_u32 s67, s66, 401408
    s_min_u32 s66, s66, s67
    buffer_load_dwordx4 v17, s[16:19], s66 offen lds
    s_waitcnt lgkmcnt(0)
    s_barrier
    ds_read_b128 v[64:67], v25 offset:0
    ds_read_b128 v[68:71], v25 offset:32
    ds_read_b128 v[72:75], v25 offset:64
    ds_read_b128 v[76:79], v25 offset:96
    s_add_u32 m0, s5, 71680
    s_add_u32 s66, s55, 372736
    s_sub_u32 s67, s66, 401408
    s_min_u32 s66, s66, s67
    buffer_load_dwordx4 v17, s[16:19], s66 offen lds
    s_waitcnt lgkmcnt(3)
    v_mfma_f32_32x32x16_bf16 v[96:111], v[64:67], v[48:51], 0
    s_waitcnt lgkmcnt(2)
    v_mfma_f32_32x32x16_bf16 v[96:111], v[68:71], v[52:55], v[96:111]
    s_waitcnt lgkmcnt(1)
    v_mfma_f32_32x32x16_bf16 v[96:111], v[72:75], v[56:59], v[96:111]
    s_waitcnt lgkmcnt(0)
    v_mfma_f32_32x32x16_bf16 v[96:111], v[76:79], v[60:63], v[96:111]
    s_nop 11
    v_add_f32 v32, v103, v31
    v_rcp_f32 v32, v32
    s_cmp_eq_u32 s99, 1
    v_mul_f32 v96, v32, v96
    v_mul_f32 v97, v32, v97
    v_mul_f32 v98, v32, v98
    v_mul_f32 v99, v32, v99
    v_mul_f32 v100, v32, v100
    v_mul_f32 v101, v32, v101
    v_mul_f32 v102, v32, v102
    v_cvt_pk_bf16_f32 v80, v96, v97
    v_cvt_pk_bf16_f32 v81, v98, v99
    v_cvt_pk_bf16_f32 v82, v100, v101
    v_cvt_pk_bf16_f32 v83, v102, v103
    v_and_or_b32 v83, v83, s96, v34
    s_cbranch_scc0 L_slow1_0
    buffer_store_dwordx4 v[80:83], v13, s[20:23], s35 offen offset:0
L_pub1_0:
    v_mul_f32 v104, v32, v104
    v_mul_f32 v105, v32, v105
    v_mul_f32 v106, v32, v106
    v_mul_f32 v107, v32, v107
    v_mul_f32 v108, v32, v108
    v_mul_f32 v109, v32, v109
    v_mul_f32 v110, v32, v110
    v_cvt_pk_bf16_f32 v84, v104, v105
    v_cvt_pk_bf16_f32 v85, v106, v107
    v_cvt_pk_bf16_f32 v86, v108, v109
    v_cvt_pk_bf16_f32 v87, v110, v111
    v_and_or_b32 v87, v87, s96, v34
    s_cbranch_scc0 L_slow1_1
    buffer_store_dwordx4 v[84:87], v13, s[20:23], s35 offen offset:1024
L_pub1_1:
    s_lshr_b32 s64, s53, 1
    s_lshr_b32 s65, s4, 2
    s_cmp_eq_u32 s64, s65
    s_cbranch_scc0 L_nown1
    ds_write_b128 v27, v[80:83] offset:0
    ds_write_b128 v27, v[84:87] offset:1024
L_nown1:
    v_and_b32 v131, s96, v131
    v_and_b32 v135, s96, v135
    v_and_b32 v139, s96, v139
    v_and_b32 v143, s96, v143
    v_and_b32 v147, s96, v147
    v_and_b32 v151, s96, v151
    v_and_b32 v155, s96, v155
    v_and_b32 v159, s96, v159
    v_and_b32 v163, s96, v163
    v_and_b32 v167, s96, v167
    v_and_b32 v171, s96, v171
    v_and_b32 v175, s96, v175
    v_and_b32 v179, s96, v179
    v_and_b32 v183, s96, v183
    v_and_b32 v187, s96, v187
    v_and_b32 v191, s96, v191
    s_waitcnt vmcnt(0)
    s_add_u32 s64, s28, 0
    s_add_u32 m0, s63, 0
    s_and_b32 s64, s64, 0x7fff
    s_add_u32 s64, s64, s62
    buffer_load_dwordx4 v13, s[20:23], s64 offen sc1 lds
    s_add_u32 s64, s28, 4096
    s_add_u32 m0, s63, 4096
    s_and_b32 s64, s64, 0x7fff
    s_add_u32 s64, s64, s62
    buffer_load_dwordx4 v13, s[20:23], s64 offen sc1 lds
    s_waitcnt lgkmcnt(0)
    s_barrier
    s_and_b32 s64, s4, 3
    s_lshl2_add_u32 s64, s64, s53
    s_cmp_ge_u32 s64, 14
    s_cbranch_scc1 L_idle1
    s_mov_b32 s73, 0
    ds_read_b128 v[112:115], v4 offset:0
    ds_read_b128 v[116:119], v4 offset:1024
    ds_read_b128 v[120:123], v4 offset:2048
    ds_read_b128 v[124:127], v4 offset:3072
    ds_read_b64_tr_b16 v[192:193], v20 offset:0
    ds_read_b64_tr_b16 v[194:195], v20 offset:1024
    ds_read_b64_tr_b16 v[196:197], v21 offset:0
    ds_read_b64_tr_b16 v[198:199], v21 offset:1024
    ds_read_b64_tr_b16 v[200:201], v20 offset:7168
    ds_read_b64_tr_b16 v[202:203], v20 offset:8192
    ds_read_b64_tr_b16 v[204:205], v21 offset:7168
    ds_read_b64_tr_b16 v[206:207], v21 offset:8192
    s_waitcnt lgkmcnt(11)
    v_mfma_f32_32x32x16_bf16 v[64:79], v[128:131], v[112:115], 0
    s_add_u32 s64, s28, 8192
    s_add_u32 m0, s63, 8192
    s_and_b32 s64, s64, 0x7fff
    s_add_u32 s64, s64, s62
    buffer_load_dwordx4 v13, s[20:23], s64 offen sc1 lds
    s_add_u32 s64, s28, 12288
    s_add_u32 m0, s63, 12288
    s_and_b32 s64, s64, 0x7fff
    s_add_u32 s64, s64, s62
    buffer_load_dwordx4 v13, s[20:23], s64 offen sc1 lds
    s_waitcnt lgkmcnt(10)
    v_mfma_f32_32x32x16_bf16 v[64:79], v[132:135], v[116:119], v[64:79]
    s_add_u32 s64, s28, 16384
    s_add_u32 m0, s63, 16384
    s_and_b32 s64, s64, 0x7fff
    s_add_u32 s64, s64, s62
    buffer_load_dwordx4 v13, s[20:23], s64 offen sc1 lds
    s_waitcnt lgkmcnt(9)
    v_mfma_f32_32x32x16_bf16 v[64:79], v[136:139], v[120:123], v[64:79]
    s_add_u32 s64, s28, 20480
    s_add_u32 m0, s63, 20480
    s_and_b32 s64, s64, 0x7fff
    s_add_u32 s64, s64, s62
    buffer_load_dwordx4 v13, s[20:23], s64 offen sc1 lds
    s_waitcnt lgkmcnt(8)
    v_mfma_f32_32x32x16_bf16 v[64:79], v[140:143], v[124:127], v[64:79]
    s_add_u32 s64, s28, 24576
    s_add_u32 m0, s63, 24576
    s_and_b32 s64, s64, 0x7fff
    s_add_u32 s64, s64, s62
    buffer_load_dwordx4 v13, s[20:23], s64 offen sc1 lds
    ds_read_b64_tr_b16 v[208:209], v20 offset:14336
    ds_read_b64_tr_b16 v[210:211], v20 offset:15360
    ds_read_b64_tr_b16 v[212:213], v21 offset:14336
    ds_read_b64_tr_b16 v[214:215], v21 offset:15360
    s_waitcnt lgkmcnt(8)
    v_and_b32 v195, s96, v195
    v_and_b32 v199, s96, v199
    ds_read_b64_tr_b16 v[216:217], v20 offset:21504
    ds_read_b64_tr_b16 v[218:219], v20 offset:22528
    ds_read_b64_tr_b16 v[220:221], v21 offset:21504
    ds_read_b64_tr_b16 v[222:223], v21 offset:22528
    v_and_b32 v44, 31, v1
    v_lshrrev_b32 v45, 5, v1
    v_mul_u32_u24 v44, 272, v44
    v_lshl_add_u32 v44, v45, 3, v44
    s_mul_i32 s48, s52, 8704
    s_waitcnt lgkmcnt(8)
    v_and_b32 v203, s96, v203
    v_and_b32 v207, s96, v207
    ds_read_b64_tr_b16 v[224:225], v20 offset:28672
    ds_read_b64_tr_b16 v[226:227], v20 offset:29696
    ds_read_b64_tr_b16 v[228:229], v21 offset:28672
    ds_read_b64_tr_b16 v[230:231], v21 offset:29696
    s_lshl_b32 s49, s53, 6
    s_add_u32 s48, s48, s49
    s_add_u32 s48, s48, 92160
    v_add_u32 v26, s48, v44
    v_lshrrev_b32 v46, 4, v0
    s_waitcnt lgkmcnt(8)
    v_and_b32 v211, s96, v211
    v_and_b32 v215, s96, v215
    ds_read_b64_tr_b16 v[232:233], v20 offset:35840
    ds_read_b64_tr_b16 v[234:235], v20 offset:36864
    ds_read_b64_tr_b16 v[236:237], v21 offset:35840
    ds_read_b64_tr_b16 v[238:239], v21 offset:36864
    v_and_b32 v47, 15, v0
    v_lshlrev_b32 v45, 4, v47
    v_mul_u32_u24 v27, 272, v46
    s_mov_b32 s48, 92160
    v_add3_u32 v27, v27, v45, s48
    s_waitcnt lgkmcnt(8)
    v_and_b32 v219, s96, v219
    v_and_b32 v223, s96, v223
    ds_read_b64_tr_b16 v[240:241], v22 offset:0
    ds_read_b64_tr_b16 v[242:243], v22 offset:1024
    ds_read_b64_tr_b16 v[244:245], v23 offset:0
    ds_read_b64_tr_b16 v[246:247], v23 offset:1024
    v_mul_u32_u24 v28, 1792, v46
    v_add_u32 v28, v28, v45
    s_and_b32 s49, s4, 3
    s_cmp_eq_u32 s49, 3
    s_cselect_b32 s48, 8, 16
    s_waitcnt lgkmcnt(8)
    v_and_b32 v227, s96, v227
    v_and_b32 v231, s96, v231
    ds_read_b64_tr_b16 v[248:249], v22 offset:7168
    ds_read_b64_tr_b16 v[250:251], v22 offset:8192
    ds_read_b64_tr_b16 v[252:253], v23 offset:7168
    ds_read_b64_tr_b16 v[254:255], v23 offset:8192
    v_cmp_le_u32 s[50:51], s48, v47
    v_mov_b32 v45, 0x40000000
    s_lshl_b32 s97, s34, 1
    s_lshr_b32 s48, s4, 2
    v_cndmask_b32_e64 v28, v28, v45, s[50:51]
    s_waitcnt lgkmcnt(8)
    v_and_b32 v235, s96, v235
    v_and_b32 v239, s96, v239
    s_add_u32 s97, s97, s48
    s_mul_i32 s97, s97, 114688
    s_lshl_b32 s48, s49, 8
    s_add_u32 s97, s97, s48
    s_add_u32 s97, s97, 896
    s_waitcnt lgkmcnt(4)
    v_and_b32 v243, s96, v243
    v_and_b32 v247, s96, v247
    s_add_u32 s58, s97, 57344
    s_waitcnt lgkmcnt(0)
    v_and_b32 v251, s96, v251
    v_and_b32 v255, s96, v255
    s_waitcnt vmcnt(5)
    ds_read_b32 v32, v15 offset:12
    ds_read_b32 v33, v15 offset:4108
    s_waitcnt lgkmcnt(0)
L_h2_1_0:
    v_xor_b32 v32, s57, v32
    v_bitop3_b32 v32, v32, s57, v33 bitop3:0xf6
    v_cmp_lt_u32 vcc, s96, v32
    s_cbranch_vccz L_h2x_1_0
    s_add_u32 s73, s73, 1
    s_cmp_ge_u32 s73, 100000
    s_cbranch_scc1 L_h2x_1_0
    s_add_u32 s64, s28, 0
    s_add_u32 m0, s63, 0
    s_and_b32 s64, s64, 0x7fff
    s_add_u32 s64, s64, s62
    buffer_load_dwordx4 v13, s[20:23], s64 offen sc1 lds
    s_add_u32 s64, s28, 4096
    s_add_u32 m0, s63, 4096
    s_and_b32 s64, s64, 0x7fff
    s_add_u32 s64, s64, s62
    buffer_load_dwordx4 v13, s[20:23], s64 offen sc1 lds
    s_add_u32 s64, s28, 8192
    s_add_u32 m0, s63, 8192
    s_and_b32 s64, s64, 0x7fff
    s_add_u32 s64, s64, s62
    buffer_load_dwordx4 v13, s[20:23], s64 offen sc1 lds
    s_add_u32 s64, s28, 12288
    s_add_u32 m0, s63, 12288
    s_and_b32 s64, s64, 0x7fff
    s_add_u32 s64, s64, s62
    buffer_load_dwordx4 v13, s[20:23], s64 offen sc1 lds
    s_add_u32 s64, s28, 16384
    s_add_u32 m0, s63, 16384
    s_and_b32 s64, s64, 0x7fff
    s_add_u32 s64, s64, s62
    buffer_load_dwordx4 v13, s[20:23], s64 offen sc1 lds
    s_add_u32 s64, s28, 20480
    s_add_u32 m0, s63, 20480
    s_and_b32 s64, s64, 0x7fff
    s_add_u32 s64, s64, s62
    buffer_load_dwordx4 v13, s[20:23], s64 offen sc1 lds
    s_add_u32 s64, s28, 24576
    s_add_u32 m0, s63, 24576
    s_and_b32 s64, s64, 0x7fff
    s_add_u32 s64, s64, s62
    buffer_load_dwordx4 v13, s[20:23], s64 offen sc1 lds
    s_waitcnt vmcnt(5)
    ds_read_b32 v32, v15 offset:12
    ds_read_b32 v33, v15 offset:4108
    s_waitcnt lgkmcnt(0)
    s_branch L_h2_1_0
L_h2x_1_0:
    s_barrier
    ds_read_b128 v[112:115], v4 offset:4096
    ds_read_b128 v[116:119], v4 offset:5120
    ds_read_b128 v[120:123], v4 offset:6144
    ds_read_b128 v[124:127], v4 offset:7168
    s_waitcnt lgkmcnt(3)
    v_mfma_f32_32x32x16_bf16 v[64:79], v[144:147], v[112:115], v[64:79]
    ds_read_b128 v[112:115], v4 offset:8192
    s_waitcnt lgkmcnt(3)
    v_mfma_f32_32x32x16_bf16 v[64:79], v[148:151], v[116:119], v[64:79]
    s_waitcnt vmcnt(3)
    ds_read_b32 v32, v15 offset:8204
    ds_read_b32 v33, v15 offset:12300
    ds_read_b128 v[116:119], v4 offset:9216
    s_waitcnt lgkmcnt(5)
    v_mfma_f32_32x32x16_bf16 v[64:79], v[152:155], v[120:123], v[64:79]
    ds_read_b128 v[120:123], v4 offset:10240
    s_waitcnt lgkmcnt(5)
    v_mfma_f32_32x32x16_bf16 v[64:79], v[156:159], v[124:127], v[64:79]
    ds_read_b128 v[124:127], v4 offset:11264
    s_waitcnt lgkmcnt(5)
    v_mfma_f32_32x32x16_bf16 v[64:79], v[160:163], v[112:115], v[64:79]
    s_waitcnt lgkmcnt(3)
L_h2_1_1:
    v_xor_b32 v32, s57, v32
    v_bitop3_b32 v32, v32, s57, v33 bitop3:0xf6
    v_cmp_lt_u32 vcc, s96, v32
    s_cbranch_vccz L_h2x_1_1
    s_add_u32 s73, s73, 1
    s_cmp_ge_u32 s73, 100000
    s_cbranch_scc1 L_h2x_1_1
    s_add_u32 s64, s28, 8192
    s_add_u32 m0, s63, 8192
    s_and_b32 s64, s64, 0x7fff
    s_add_u32 s64, s64, s62
    buffer_load_dwordx4 v13, s[20:23], s64 offen sc1 lds
    s_add_u32 s64, s28, 12288
    s_add_u32 m0, s63, 12288
    s_and_b32 s64, s64, 0x7fff
    s_add_u32 s64, s64, s62
    buffer_load_dwordx4 v13, s[20:23], s64 offen sc1 lds
    s_add_u32 s64, s28, 16384
    s_add_u32 m0, s63, 16384
    s_and_b32 s64, s64, 0x7fff
    s_add_u32 s64, s64, s62
    buffer_load_dwordx4 v13, s[20:23], s64 offen sc1 lds
    s_add_u32 s64, s28, 20480
    s_add_u32 m0, s63, 20480
    s_and_b32 s64, s64, 0x7fff
    s_add_u32 s64, s64, s62
    buffer_load_dwordx4 v13, s[20:23], s64 offen sc1 lds
    s_add_u32 s64, s28, 24576
    s_add_u32 m0, s63, 24576
    s_and_b32 s64, s64, 0x7fff
    s_add_u32 s64, s64, s62
    buffer_load_dwordx4 v13, s[20:23], s64 offen sc1 lds
    s_waitcnt vmcnt(3)
    ds_read_b32 v32, v15 offset:8204
    ds_read_b32 v33, v15 offset:12300
    s_waitcnt lgkmcnt(0)
    s_branch L_h2_1_1
L_h2x_1_1:
    s_barrier
    ds_read_b128 v[112:115], v4 offset:12288
    s_waitcnt lgkmcnt(3)
    v_mfma_f32_32x32x16_bf16 v[64:79], v[164:167], v[116:119], v[64:79]
    ds_read_b128 v[116:119], v4 offset:13312
    s_waitcnt lgkmcnt(3)
    v_mfma_f32_32x32x16_bf16 v[64:79], v[168:171], v[120:123], v[64:79]
    ds_read_b128 v[120:123], v4 offset:14336
    s_waitcnt lgkmcnt(3)
    v_mfma_f32_32x32x16_bf16 v[64:79], v[172:175], v[124:127], v[64:79]
    ds_read_b128 v[124:127], v4 offset:15360
    s_waitcnt lgkmcnt(3)
    v_mfma_f32_32x32x16_bf16 v[64:79], v[176:179], v[112:115], v[64:79]
    ds_read_b128 v[112:115], v4 offset:16384
    s_waitcnt lgkmcnt(3)
    v_mfma_f32_32x32x16_bf16 v[64:79], v[180:183], v[116:119], v[64:79]
    s_waitcnt vmcnt(0)
    ds_read_b32 v32, v15 offset:16396
    ds_read_b32 v33, v15 offset:20492
    ds_read_b32 v35, v15 offset:24588
    ds_read_b128 v[116:119], v4 offset:17408
    s_waitcnt lgkmcnt(6)
    v_mfma_f32_32x32x16_bf16 v[64:79], v[184:187], v[120:123], v[64:79]
    ds_read_b128 v[120:123], v4 offset:18432
    s_waitcnt lgkmcnt(6)
    v_mfma_f32_32x32x16_bf16 v[64:79], v[188:191], v[124:127], v[64:79]
    ds_read_b128 v[124:127], v4 offset:19456
    s_waitcnt lgkmcnt(6)
    v_mfma_f32_32x32x16_bf16 v[64:79], v[192:195], v[112:115], v[64:79]
    s_waitcnt lgkmcnt(3)
L_h2_1_2:
    v_xor_b32 v32, s57, v32
    v_bitop3_b32 v32, v32, s57, v33 bitop3:0xf6
    v_bitop3_b32 v32, v32, s57, v35 bitop3:0xf6
    v_cmp_lt_u32 vcc, s96, v32
    s_cbranch_vccz L_h2x_1_2
    s_add_u32 s73, s73, 1
    s_cmp_ge_u32 s73, 100000
    s_cbranch_scc1 L_h2x_1_2
    s_add_u32 s64, s28, 16384
    s_add_u32 m0, s63, 16384
    s_and_b32 s64, s64, 0x7fff
    s_add_u32 s64, s64, s62
    buffer_load_dwordx4 v13, s[20:23], s64 offen sc1 lds
    s_add_u32 s64, s28, 20480
    s_add_u32 m0, s63, 20480
    s_and_b32 s64, s64, 0x7fff
    s_add_u32 s64, s64, s62
    buffer_load_dwordx4 v13, s[20:23], s64 offen sc1 lds
    s_add_u32 s64, s28, 24576
    s_add_u32 m0, s63, 24576
    s_and_b32 s64, s64, 0x7fff
    s_add_u32 s64, s64, s62
    buffer_load_dwordx4 v13, s[20:23], s64 offen sc1 lds
    s_waitcnt vmcnt(0)
    ds_read_b32 v32, v15 offset:16396
    ds_read_b32 v33, v15 offset:20492
    ds_read_b32 v35, v15 offset:24588
    s_waitcnt lgkmcnt(0)
    s_branch L_h2_1_2
L_h2x_1_2:
    s_barrier
    ds_read_b128 v[112:115], v4 offset:20480
    s_waitcnt lgkmcnt(3)
    v_mfma_f32_32x32x16_bf16 v[64:79], v[196:199], v[116:119], v[64:79]
    ds_read_b128 v[116:119], v4 offset:21504
    s_waitcnt lgkmcnt(3)
    v_mfma_f32_32x32x16_bf16 v[64:79], v[200:203], v[120:123], v[64:79]
    ds_read_b128 v[120:123], v4 offset:22528
    s_waitcnt lgkmcnt(3)
    v_mfma_f32_32x32x16_bf16 v[64:79], v[204:207], v[124:127], v[64:79]
    ds_read_b128 v[124:127], v4 offset:23552
    s_waitcnt lgkmcnt(3)
    v_mfma_f32_32x32x16_bf16 v[64:79], v[208:211], v[112:115], v[64:79]
    ds_read_b128 v[112:115], v4 offset:24576
    s_waitcnt lgkmcnt(3)
    v_mfma_f32_32x32x16_bf16 v[64:79], v[212:215], v[116:119], v[64:79]
    ds_read_b128 v[116:119], v4 offset:25600
    s_waitcnt lgkmcnt(3)
    v_mfma_f32_32x32x16_bf16 v[64:79], v[216:219], v[120:123], v[64:79]
    ds_read_b128 v[120:123], v4 offset:26624
    s_waitcnt lgkmcnt(3)
    v_mfma_f32_32x32x16_bf16 v[64:79], v[220:223], v[124:127], v[64:79]
    ds_read_b128 v[124:127], v4 offset:27648
    s_waitcnt lgkmcnt(3)
    v_mfma_f32_32x32x16_bf16 v[64:79], v[224:227], v[112:115], v[64:79]
    ds_read_b128 v[112:115], v4 offset:28672
    s_waitcnt lgkmcnt(3)
    v_mfma_f32_32x32x16_bf16 v[64:79], v[228:231], v[116:119], v[64:79]
    ds_read_b128 v[116:119], v4 offset:29696
    s_waitcnt lgkmcnt(3)
    v_mfma_f32_32x32x16_bf16 v[64:79], v[232:235], v[120:123], v[64:79]
    ds_read_b128 v[120:123], v4 offset:30720
    s_waitcnt lgkmcnt(3)
    v_mfma_f32_32x32x16_bf16 v[64:79], v[236:239], v[124:127], v[64:79]
    ds_read_b128 v[124:127], v4 offset:31744
    s_waitcnt lgkmcnt(3)
    v_mfma_f32_32x32x16_bf16 v[64:79], v[240:243], v[112:115], v[64:79]
    s_waitcnt lgkmcnt(2)
    v_mfma_f32_32x32x16_bf16 v[64:79], v[244:247], v[116:119], v[64:79]
    s_or_b32 s64, s3, s32
    s_cmp_eq_u32 s64, 0
    s_cbranch_scc0 L_noe1
    s_or_b32 s64, s56, s57
    v_mov_b32 v32, s64
    v_mov_b32 v33, 256
    s_mov_b64 exec, 1
    buffer_store_dword v32, v33, s[20:23], 0 offen sc1
    s_mov_b64 exec, -1
L_noe1:
    s_waitcnt lgkmcnt(1)
    v_mfma_f32_32x32x16_bf16 v[64:79], v[248:251], v[120:123], v[64:79]
    s_waitcnt lgkmcnt(0)
    v_mfma_f32_32x32x16_bf16 v[64:79], v[252:255], v[124:127], v[64:79]
    s_nop 11
    v_cvt_pk_bf16_f32 v88, v64, v65
    v_cvt_pk_bf16_f32 v89, v66, v67
    ds_write_b64 v26, v[88:89] offset:0
    v_cvt_pk_bf16_f32 v90, v68, v69
    v_cvt_pk_bf16_f32 v91, v70, v71
    ds_write_b64 v26, v[90:91] offset:16
    v_cvt_pk_bf16_f32 v92, v72, v73
    v_cvt_pk_bf16_f32 v93, v74, v75
    ds_write_b64 v26, v[92:93] offset:32
    v_cvt_pk_bf16_f32 v94, v76, v77
    v_cvt_pk_bf16_f32 v95, v78, v79
    ds_write_b64 v26, v[94:95] offset:48
L_join1:
    s_waitcnt lgkmcnt(0)
    s_barrier
    ds_read_b128 v[96:99], v27
    ds_read_b128 v[100:103], v27 offset:8704
    s_waitcnt lgkmcnt(1)
    buffer_store_dwordx4 v[96:99], v28, s[24:27], s97 offen sc1
    s_waitcnt lgkmcnt(0)
    buffer_store_dwordx4 v[100:103], v28, s[24:27], s58 offen sc1
    s_endpgm
L_idle1:
    v_and_b32 v44, 31, v1
    v_lshrrev_b32 v45, 5, v1
    v_mul_u32_u24 v44, 272, v44
    v_lshl_add_u32 v44, v45, 3, v44
    s_mul_i32 s48, s52, 8704
    s_lshl_b32 s49, s53, 6
    s_add_u32 s48, s48, s49
    s_add_u32 s48, s48, 92160
    v_add_u32 v26, s48, v44
    v_lshrrev_b32 v46, 4, v0
    v_and_b32 v47, 15, v0
    v_lshlrev_b32 v45, 4, v47
    v_mul_u32_u24 v27, 272, v46
    s_mov_b32 s48, 92160
    v_add3_u32 v27, v27, v45, s48
    v_mul_u32_u24 v28, 1792, v46
    v_add_u32 v28, v28, v45
    s_and_b32 s49, s4, 3
    s_cmp_eq_u32 s49, 3
    s_cselect_b32 s48, 8, 16
    v_cmp_le_u32 s[50:51], s48, v47
    v_mov_b32 v45, 0x40000000
    s_lshl_b32 s97, s34, 1
    s_lshr_b32 s48, s4, 2
    v_cndmask_b32_e64 v28, v28, v45, s[50:51]
    s_add_u32 s97, s97, s48
    s_mul_i32 s97, s97, 114688
    s_lshl_b32 s48, s49, 8
    s_add_u32 s97, s97, s48
    s_add_u32 s97, s97, 896
    s_add_u32 s58, s97, 57344
    s_mov_b32 s73, 0
    s_lshl_b32 s64, s4, 3
    s_add_u32 s64, s64, s32
    s_lshl_b32 s65, s101, 8
    s_add_u32 s64, s64, s65
    s_cmp_eq_u32 s64, 26
    s_cbranch_scc0 L_idle21
    s_add_u32 s64, s28, 8192
    s_add_u32 m0, s63, 8192
    s_and_b32 s64, s64, 0x7fff
    s_add_u32 s64, s64, s62
    buffer_load_dwordx4 v13, s[20:23], s64 offen sc1 lds
    s_add_u32 s64, s28, 12288
    s_add_u32 m0, s63, 12288
    s_and_b32 s64, s64, 0x7fff
    s_add_u32 s64, s64, s62
    buffer_load_dwordx4 v13, s[20:23], s64 offen sc1 lds
    s_add_u32 s64, s28, 16384
    s_add_u32 m0, s63, 16384
    s_and_b32 s64, s64, 0x7fff
    s_add_u32 s64, s64, s62
    buffer_load_dwordx4 v13, s[20:23], s64 offen sc1 lds
    s_add_u32 s64, s28, 20480
    s_add_u32 m0, s63, 20480
    s_and_b32 s64, s64, 0x7fff
    s_add_u32 s64, s64, s62
    buffer_load_dwordx4 v13, s[20:23], s64 offen sc1 lds
    s_add_u32 s64, s28, 24576
    s_add_u32 m0, s63, 24576
    s_and_b32 s64, s64, 0x7fff
    s_add_u32 s64, s64, s62
    buffer_load_dwordx4 v13, s[20:23], s64 offen sc1 lds
    s_waitcnt vmcnt(5)
    ds_read_b32 v32, v15 offset:12
    ds_read_b32 v33, v15 offset:4108
    s_waitcnt lgkmcnt(0)
L_h2_1iw_0:
    v_xor_b32 v32, s57, v32
    v_bitop3_b32 v32, v32, s57, v33 bitop3:0xf6
    v_cmp_lt_u32 vcc, s96, v32
    s_cbranch_vccz L_h2x_1iw_0
    s_add_u32 s73, s73, 1
    s_cmp_ge_u32 s73, 100000
    s_cbranch_scc1 L_h2x_1iw_0
    s_add_u32 s64, s28, 0
    s_add_u32 m0, s63, 0
    s_and_b32 s64, s64, 0x7fff
    s_add_u32 s64, s64, s62
    buffer_load_dwordx4 v13, s[20:23], s64 offen sc1 lds
    s_add_u32 s64, s28, 4096
    s_add_u32 m0, s63, 4096
    s_and_b32 s64, s64, 0x7fff
    s_add_u32 s64, s64, s62
    buffer_load_dwordx4 v13, s[20:23], s64 offen sc1 lds
    s_add_u32 s64, s28, 8192
    s_add_u32 m0, s63, 8192
    s_and_b32 s64, s64, 0x7fff
    s_add_u32 s64, s64, s62
    buffer_load_dwordx4 v13, s[20:23], s64 offen sc1 lds
    s_add_u32 s64, s28, 12288
    s_add_u32 m0, s63, 12288
    s_and_b32 s64, s64, 0x7fff
    s_add_u32 s64, s64, s62
    buffer_load_dwordx4 v13, s[20:23], s64 offen sc1 lds
    s_add_u32 s64, s28, 16384
    s_add_u32 m0, s63, 16384
    s_and_b32 s64, s64, 0x7fff
    s_add_u32 s64, s64, s62
    buffer_load_dwordx4 v13, s[20:23], s64 offen sc1 lds
    s_add_u32 s64, s28, 20480
    s_add_u32 m0, s63, 20480
    s_and_b32 s64, s64, 0x7fff
    s_add_u32 s64, s64, s62
    buffer_load_dwordx4 v13, s[20:23], s64 offen sc1 lds
    s_add_u32 s64, s28, 24576
    s_add_u32 m0, s63, 24576
    s_and_b32 s64, s64, 0x7fff
    s_add_u32 s64, s64, s62
    buffer_load_dwordx4 v13, s[20:23], s64 offen sc1 lds
    s_waitcnt vmcnt(0)
    ds_read_b32 v32, v15 offset:12
    ds_read_b32 v33, v15 offset:4108
    s_waitcnt lgkmcnt(0)
    s_branch L_h2_1iw_0
L_h2x_1iw_0:
    s_barrier
    s_waitcnt vmcnt(3)
    ds_read_b32 v32, v15 offset:8204
    ds_read_b32 v33, v15 offset:12300
    s_waitcnt lgkmcnt(0)
L_h2_1iw_1:
    v_xor_b32 v32, s57, v32
    v_bitop3_b32 v32, v32, s57, v33 bitop3:0xf6
    v_cmp_lt_u32 vcc, s96, v32
    s_cbranch_vccz L_h2x_1iw_1
    s_add_u32 s73, s73, 1
    s_cmp_ge_u32 s73, 100000
    s_cbranch_scc1 L_h2x_1iw_1
    s_add_u32 s64, s28, 8192
    s_add_u32 m0, s63, 8192
    s_and_b32 s64, s64, 0x7fff
    s_add_u32 s64, s64, s62
    buffer_load_dwordx4 v13, s[20:23], s64 offen sc1 lds
    s_add_u32 s64, s28, 12288
    s_add_u32 m0, s63, 12288
    s_and_b32 s64, s64, 0x7fff
    s_add_u32 s64, s64, s62
    buffer_load_dwordx4 v13, s[20:23], s64 offen sc1 lds
    s_add_u32 s64, s28, 16384
    s_add_u32 m0, s63, 16384
    s_and_b32 s64, s64, 0x7fff
    s_add_u32 s64, s64, s62
    buffer_load_dwordx4 v13, s[20:23], s64 offen sc1 lds
    s_add_u32 s64, s28, 20480
    s_add_u32 m0, s63, 20480
    s_and_b32 s64, s64, 0x7fff
    s_add_u32 s64, s64, s62
    buffer_load_dwordx4 v13, s[20:23], s64 offen sc1 lds
    s_add_u32 s64, s28, 24576
    s_add_u32 m0, s63, 24576
    s_and_b32 s64, s64, 0x7fff
    s_add_u32 s64, s64, s62
    buffer_load_dwordx4 v13, s[20:23], s64 offen sc1 lds
    s_waitcnt vmcnt(0)
    ds_read_b32 v32, v15 offset:8204
    ds_read_b32 v33, v15 offset:12300
    s_waitcnt lgkmcnt(0)
    s_branch L_h2_1iw_1
L_h2x_1iw_1:
    s_barrier
    s_waitcnt vmcnt(0)
    ds_read_b32 v32, v15 offset:16396
    ds_read_b32 v33, v15 offset:20492
    ds_read_b32 v35, v15 offset:24588
    s_waitcnt lgkmcnt(0)
L_h2_1iw_2:
    v_xor_b32 v32, s57, v32
    v_bitop3_b32 v32, v32, s57, v33 bitop3:0xf6
    v_bitop3_b32 v32, v32, s57, v35 bitop3:0xf6
    v_cmp_lt_u32 vcc, s96, v32
    s_cbranch_vccz L_h2x_1iw_2
    s_add_u32 s73, s73, 1
    s_cmp_ge_u32 s73, 100000
    s_cbranch_scc1 L_h2x_1iw_2
    s_add_u32 s64, s28, 16384
    s_add_u32 m0, s63, 16384
    s_and_b32 s64, s64, 0x7fff
    s_add_u32 s64, s64, s62
    buffer_load_dwordx4 v13, s[20:23], s64 offen sc1 lds
    s_add_u32 s64, s28, 20480
    s_add_u32 m0, s63, 20480
    s_and_b32 s64, s64, 0x7fff
    s_add_u32 s64, s64, s62
    buffer_load_dwordx4 v13, s[20:23], s64 offen sc1 lds
    s_add_u32 s64, s28, 24576
    s_add_u32 m0, s63, 24576
    s_and_b32 s64, s64, 0x7fff
    s_add_u32 s64, s64, s62
    buffer_load_dwordx4 v13, s[20:23], s64 offen sc1 lds
    s_waitcnt vmcnt(0)
    ds_read_b32 v32, v15 offset:16396
    ds_read_b32 v33, v15 offset:20492
    ds_read_b32 v35, v15 offset:24588
    s_waitcnt lgkmcnt(0)
    s_branch L_h2_1iw_2
L_h2x_1iw_2:
    s_barrier
    buffer_wbl2 sc1
    s_branch L_join1
L_idle21:
    s_add_u32 s64, s28, 8192
    s_add_u32 m0, s63, 8192
    s_and_b32 s64, s64, 0x7fff
    s_add_u32 s64, s64, s62
    buffer_load_dwordx4 v13, s[20:23], s64 offen sc1 lds
    s_add_u32 s64, s28, 12288
    s_add_u32 m0, s63, 12288
    s_and_b32 s64, s64, 0x7fff
    s_add_u32 s64, s64, s62
    buffer_load_dwordx4 v13, s[20:23], s64 offen sc1 lds
    s_add_u32 s64, s28, 16384
    s_add_u32 m0, s63, 16384
    s_and_b32 s64, s64, 0x7fff
    s_add_u32 s64, s64, s62
    buffer_load_dwordx4 v13, s[20:23], s64 offen sc1 lds
    s_add_u32 s64, s28, 20480
    s_add_u32 m0, s63, 20480
    s_and_b32 s64, s64, 0x7fff
    s_add_u32 s64, s64, s62
    buffer_load_dwordx4 v13, s[20:23], s64 offen sc1 lds
    s_add_u32 s64, s28, 24576
    s_add_u32 m0, s63, 24576
    s_and_b32 s64, s64, 0x7fff
    s_add_u32 s64, s64, s62
    buffer_load_dwordx4 v13, s[20:23], s64 offen sc1 lds
    s_waitcnt vmcnt(5)
    ds_read_b32 v32, v15 offset:12
    ds_read_b32 v33, v15 offset:4108
    s_waitcnt lgkmcnt(0)
L_h2_1i_0:
    v_xor_b32 v32, s57, v32
    v_bitop3_b32 v32, v32, s57, v33 bitop3:0xf6
    v_cmp_lt_u32 vcc, s96, v32
    s_cbranch_vccz L_h2x_1i_0
    s_add_u32 s73, s73, 1
    s_cmp_ge_u32 s73, 100000
    s_cbranch_scc1 L_h2x_1i_0
    s_add_u32 s64, s28, 0
    s_add_u32 m0, s63, 0
    s_and_b32 s64, s64, 0x7fff
    s_add_u32 s64, s64, s62
    buffer_load_dwordx4 v13, s[20:23], s64 offen sc1 lds
    s_add_u32 s64, s28, 4096
    s_add_u32 m0, s63, 4096
    s_and_b32 s64, s64, 0x7fff
    s_add_u32 s64, s64, s62
    buffer_load_dwordx4 v13, s[20:23], s64 offen sc1 lds
    s_add_u32 s64, s28, 8192
    s_add_u32 m0, s63, 8192
    s_and_b32 s64, s64, 0x7fff
    s_add_u32 s64, s64, s62
    buffer_load_dwordx4 v13, s[20:23], s64 offen sc1 lds
    s_add_u32 s64, s28, 12288
    s_add_u32 m0, s63, 12288
    s_and_b32 s64, s64, 0x7fff
    s_add_u32 s64, s64, s62
    buffer_load_dwordx4 v13, s[20:23], s64 offen sc1 lds
    s_add_u32 s64, s28, 16384
    s_add_u32 m0, s63, 16384
    s_and_b32 s64, s64, 0x7fff
    s_add_u32 s64, s64, s62
    buffer_load_dwordx4 v13, s[20:23], s64 offen sc1 lds
    s_add_u32 s64, s28, 20480
    s_add_u32 m0, s63, 20480
    s_and_b32 s64, s64, 0x7fff
    s_add_u32 s64, s64, s62
    buffer_load_dwordx4 v13, s[20:23], s64 offen sc1 lds
    s_add_u32 s64, s28, 24576
    s_add_u32 m0, s63, 24576
    s_and_b32 s64, s64, 0x7fff
    s_add_u32 s64, s64, s62
    buffer_load_dwordx4 v13, s[20:23], s64 offen sc1 lds
    s_waitcnt vmcnt(5)
    ds_read_b32 v32, v15 offset:12
    ds_read_b32 v33, v15 offset:4108
    s_waitcnt lgkmcnt(0)
    s_branch L_h2_1i_0
L_h2x_1i_0:
    s_barrier
    s_waitcnt vmcnt(3)
    ds_read_b32 v32, v15 offset:8204
    ds_read_b32 v33, v15 offset:12300
    s_waitcnt lgkmcnt(0)
L_h2_1i_1:
    v_xor_b32 v32, s57, v32
    v_bitop3_b32 v32, v32, s57, v33 bitop3:0xf6
    v_cmp_lt_u32 vcc, s96, v32
    s_cbranch_vccz L_h2x_1i_1
    s_add_u32 s73, s73, 1
    s_cmp_ge_u32 s73, 100000
    s_cbranch_scc1 L_h2x_1i_1
    s_add_u32 s64, s28, 8192
    s_add_u32 m0, s63, 8192
    s_and_b32 s64, s64, 0x7fff
    s_add_u32 s64, s64, s62
    buffer_load_dwordx4 v13, s[20:23], s64 offen sc1 lds
    s_add_u32 s64, s28, 12288
    s_add_u32 m0, s63, 12288
    s_and_b32 s64, s64, 0x7fff
    s_add_u32 s64, s64, s62
    buffer_load_dwordx4 v13, s[20:23], s64 offen sc1 lds
    s_add_u32 s64, s28, 16384
    s_add_u32 m0, s63, 16384
    s_and_b32 s64, s64, 0x7fff
    s_add_u32 s64, s64, s62
    buffer_load_dwordx4 v13, s[20:23], s64 offen sc1 lds
    s_add_u32 s64, s28, 20480
    s_add_u32 m0, s63, 20480
    s_and_b32 s64, s64, 0x7fff
    s_add_u32 s64, s64, s62
    buffer_load_dwordx4 v13, s[20:23], s64 offen sc1 lds
    s_add_u32 s64, s28, 24576
    s_add_u32 m0, s63, 24576
    s_and_b32 s64, s64, 0x7fff
    s_add_u32 s64, s64, s62
    buffer_load_dwordx4 v13, s[20:23], s64 offen sc1 lds
    s_waitcnt vmcnt(3)
    ds_read_b32 v32, v15 offset:8204
    ds_read_b32 v33, v15 offset:12300
    s_waitcnt lgkmcnt(0)
    s_branch L_h2_1i_1
L_h2x_1i_1:
    s_barrier
    s_waitcnt vmcnt(0)
    ds_read_b32 v32, v15 offset:16396
    ds_read_b32 v33, v15 offset:20492
    ds_read_b32 v35, v15 offset:24588
    s_waitcnt lgkmcnt(0)
L_h2_1i_2:
    v_xor_b32 v32, s57, v32
    v_bitop3_b32 v32, v32, s57, v33 bitop3:0xf6
    v_bitop3_b32 v32, v32, s57, v35 bitop3:0xf6
    v_cmp_lt_u32 vcc, s96, v32
    s_cbranch_vccz L_h2x_1i_2
    s_add_u32 s73, s73, 1
    s_cmp_ge_u32 s73, 100000
    s_cbranch_scc1 L_h2x_1i_2
    s_add_u32 s64, s28, 16384
    s_add_u32 m0, s63, 16384
    s_and_b32 s64, s64, 0x7fff
    s_add_u32 s64, s64, s62
    buffer_load_dwordx4 v13, s[20:23], s64 offen sc1 lds
    s_add_u32 s64, s28, 20480
    s_add_u32 m0, s63, 20480
    s_and_b32 s64, s64, 0x7fff
    s_add_u32 s64, s64, s62
    buffer_load_dwordx4 v13, s[20:23], s64 offen sc1 lds
    s_add_u32 s64, s28, 24576
    s_add_u32 m0, s63, 24576
    s_and_b32 s64, s64, 0x7fff
    s_add_u32 s64, s64, s62
    buffer_load_dwordx4 v13, s[20:23], s64 offen sc1 lds
    s_waitcnt vmcnt(0)
    ds_read_b32 v32, v15 offset:16396
    ds_read_b32 v33, v15 offset:20492
    ds_read_b32 v35, v15 offset:24588
    s_waitcnt lgkmcnt(0)
    s_branch L_h2_1i_2
L_h2x_1i_2:
    s_barrier
    s_nop 1
    s_branch L_join1
L_p1s1:
    buffer_store_dwordx4 v[120:123], v13, s[20:23], s64 offen sc1
    s_nop 1
    s_branch L_p1j1
L_slow1_0:
    buffer_store_dwordx4 v[80:83], v13, s[20:23], s35 offen offset:0 sc1
    s_nop 1
    s_branch L_pub1_0
L_slow1_1:
    buffer_store_dwordx4 v[84:87], v13, s[20:23], s35 offen offset:1024 sc1
    s_nop 1
    s_branch L_pub1_1
L_A:
    s_mov_b32 s16, s40
    s_mov_b32 s17, s41
    s_mov_b32 s18, 401408
    s_mov_b32 s19, 0x20000
    s_mov_b32 s24, s50
    s_mov_b32 s25, s51
    s_mov_b32 s26, 3670016
    s_mov_b32 s27, 0x20000
    s_mov_b32 s36, s78
    s_mov_b32 s37, s79
    s_mov_b32 s38, s62
    s_add_u32 s39, s38, 4096
    s_cmp_eq_u32 s39, 28672
    s_cselect_b32 s39, 0, s39
    s_add_u32 s40, s39, 4096
    s_cmp_eq_u32 s40, 28672
    s_cselect_b32 s40, 0, s40
    s_add_u32 s41, s40, 4096
    s_cmp_eq_u32 s41, 28672
    s_cselect_b32 s41, 0, s41
    s_add_u32 s42, s41, 4096
    s_cmp_eq_u32 s42, 28672
    s_cselect_b32 s42, 0, s42
    s_lshr_b32 s52, s32, 2
    s_and_b32 s53, s32, 3
    v_and_b32 v32, 31, v1
    v_lshrrev_b32 v33, 5, v1
    v_bfe_u32 v34, v1, 1, 3
    v_xor_b32 v34, v34, v33
    v_lshlrev_b32 v35, 7, v32
    v_lshl_add_u32 v35, v34, 4, v35
    s_lshl_b32 s64, s53, 12
    s_add_u32 s64, s64, 57344
    v_add_u32 v7, s64, v35
    v_xor_b32 v8, 32, v7
    v_xor_b32 v9, 64, v7
    v_xor_b32 v10, 96, v7
    v_bfe_u32 v34, v1, 2, 2
    v_lshl_add_u32 v34, v33, 3, v34
    v_bfe_u32 v35, v1, 4, 1
    v_and_b32 v32, 3, v1
    v_lshl_add_u32 v35, v35, 2, v32
    v_min_u32 v35, 6, v35
    s_mul_i32 s64, s52, 7
    v_add_lshl_u32 v35, v35, s64, 3
    v_bfe_u32 v32, v1, 3, 1
    v_lshlrev_b32 v32, 6, v32
    v_xor_b32 v35, v35, v32
    v_lshl_add_u32 v16, v34, 7, v35
    v_add_u32 v11, 106496, v16
    v_add_u32 v12, 57344, v16
    s_mov_b32 s74, 0x358637bd
    v_mov_b32 v64, s74
    v_mov_b32 v65, s74
    v_mov_b32 v66, s74
    v_mov_b32 v67, s74
    v_mov_b32 v68, s74
    v_mov_b32 v69, s74
    v_mov_b32 v70, s74
    v_mov_b32 v71, s74
    v_mov_b32 v72, s74
    v_mov_b32 v73, s74
    v_mov_b32 v74, s74
    v_mov_b32 v75, s74
    v_mov_b32 v76, s74
    v_mov_b32 v77, s74
    v_mov_b32 v78, s74
    v_mov_b32 v79, s74
    s_mul_i32 s65, s37, 42
    s_add_u32 m0, s60, 7296
    s_add_u32 s65, s65, s59
    buffer_load_dwordx4 v6, s[12:15], s65 offen offset:896 lds
    s_lshr_b32 s64, s37, 5
    s_add_u32 m0, s61, 73728
    s_add_u32 s64, s64, s58
    buffer_load_dwordx4 v2, s[8:11], s64 offen lds
    buffer_load_dwordx4 v3, s[8:11], s64 offen offset:1024 lds
    s_waitcnt vmcnt(3)
    s_barrier
    ds_read_b128 v[128:131], v7 offset:0
    ds_read_b64_tr_b16 v[48:49], v11 offset:0
    ds_read_b64_tr_b16 v[50:51], v11 offset:512
    ds_read_b128 v[132:135], v8 offset:0
    ds_read_b64_tr_b16 v[52:53], v11 offset:2048
    ds_read_b64_tr_b16 v[54:55], v11 offset:2560
    ds_read_b128 v[136:139], v9 offset:0
    ds_read_b64_tr_b16 v[56:57], v11 offset:4096
    ds_read_b64_tr_b16 v[58:59], v11 offset:4608
    ds_read_b128 v[140:143], v10 offset:0
    ds_read_b64_tr_b16 v[60:61], v11 offset:6144
    ds_read_b64_tr_b16 v[62:63], v11 offset:6656
    s_waitcnt lgkmcnt(9)
    v_mfma_f32_32x32x16_bf16 v[64:79], v[48:51], v[128:131], v[64:79]
    s_mov_b32 s70, 0
    s_mov_b32 s71, -1
    s_mov_b32 s72, 0x3fb8aa3b
    s_mov_b32 s96, 0xffff
    v_readfirstlane_b32 s29, v14
    s_getreg_b32 s98, hwreg(HW_REG_XCC_ID, 0, 4)
    s_lshl3_add_u32 s3, s34, s33
    s_lshr_b32 s30, s29, 16
    s_mul_i32 s65, s38, 42
    s_add_u32 m0, s60, 15488
    s_add_u32 s65, s65, s59
    buffer_load_dwordx4 v6, s[12:15], s65 offen offset:896 lds
    s_lshr_b32 s64, s38, 5
    s_add_u32 m0, s61, 90112
    s_add_u32 s64, s64, s58
    buffer_load_dwordx4 v2, s[8:11], s64 offen lds
    buffer_load_dwordx4 v3, s[8:11], s64 offen offset:1024 lds
    s_waitcnt lgkmcnt(6)
    v_mfma_f32_32x32x16_bf16 v[64:79], v[52:55], v[132:135], v[64:79]
    s_add_u32 s29, s29, 1
    s_and_b32 s29, s29, 0x3fff
    s_add_u32 s56, s29, 1
    s_and_b32 s56, s56, 0x3fff
    s_xor_b32 s30, s30, s29
    s_and_b32 s30, s30, 0xdfff
    s_cselect_b32 s56, s29, s56
    s_lshl_b32 s57, s56, 16
    s_waitcnt lgkmcnt(0)
    v_mfma_f32_32x32x16_bf16 v[64:79], v[56:59], v[136:139], v[64:79]
    s_waitcnt vmcnt(3)
    s_barrier
    ds_read_b128 v[144:147], v7 offset:16384
    ds_read_b64_tr_b16 v[48:49], v11 offset:8192
    ds_read_b64_tr_b16 v[50:51], v11 offset:8704
    ds_read_b128 v[148:151], v8 offset:16384
    ds_read_b64_tr_b16 v[52:53], v11 offset:10240
    ds_read_b64_tr_b16 v[54:55], v11 offset:10752
    v_mfma_f32_32x32x16_bf16 v[64:79], v[60:63], v[140:143], v[64:79]
    ds_read_b128 v[152:155], v9 offset:16384
    ds_read_b64_tr_b16 v[56:57], v11 offset:12288
    ds_read_b64_tr_b16 v[58:59], v11 offset:12800
    ds_read_b128 v[156:159], v10 offset:16384
    ds_read_b64_tr_b16 v[60:61], v11 offset:14336
    ds_read_b64_tr_b16 v[62:63], v11 offset:14848
    s_mul_i32 s65, s39, 42
    s_add_u32 m0, s60, -896
    s_add_u32 s65, s65, s59
    buffer_load_dwordx4 v6, s[12:15], s65 offen offset:896 lds
    s_lshr_b32 s64, s39, 5
    s_add_u32 m0, s61, 57344
    s_add_u32 s64, s64, s58
    buffer_load_dwordx4 v2, s[8:11], s64 offen lds
    buffer_load_dwordx4 v3, s[8:11], s64 offen offset:1024 lds
    s_or_b32 s98, s98, s57
    s_xor_b32 s47, s56, 8192
    s_lshl_b32 s69, s34, 17
    s_add_u32 s69, s69, 4194304
    s_lshl_b32 s48, s33, 12
    s_add_u32 s100, s48, s69
    v_bfe_u32 v26, v1, 3, 2
    v_lshlrev_b32 v26, 15, v26
    v_lshrrev_b32 v44, 5, v1
    v_lshl_add_u32 v26, v44, 11, v26
    v_and_b32 v44, 7, v1
    v_lshl_add_u32 v26, v44, 7, v26
    s_waitcnt lgkmcnt(9)
    v_mfma_f32_32x32x16_bf16 v[64:79], v[48:51], v[144:147], v[64:79]
    s_lshl_b32 s48, s53, 15
    s_add_u32 s35, s100, s48
    s_lshl_b32 s48, s52, 11
    s_add_u32 s35, s35, s48
    s_lshl1_add_u32 s49, s101, s32
    s_lshl_b32 s48, s101, 17
    s_sub_u32 s45, s100, s48
    s_and_b32 s48, s49, 3
    s_waitcnt lgkmcnt(6)
    v_mfma_f32_32x32x16_bf16 v[64:79], v[52:55], v[148:151], v[64:79]
    s_lshl_b32 s48, s48, 15
    s_add_u32 s45, s45, s48
    s_lshr_b32 s48, s49, 2
    s_lshl_b32 s48, s48, 11
    s_add_u32 s45, s45, s48
    s_lshl_b32 s49, s49, 10
    s_lshl_b32 s68, s33, 15
    s_add_u32 s68, s68, 3145728
    s_waitcnt lgkmcnt(0)
    v_mfma_f32_32x32x16_bf16 v[64:79], v[56:59], v[152:155], v[64:79]
    s_waitcnt vmcnt(3)
    s_barrier
    ds_read_b128 v[160:163], v7 offset:32768
    ds_read_b64_tr_b16 v[48:49], v11 offset:16384
    ds_read_b64_tr_b16 v[50:51], v11 offset:16896
    ds_read_b128 v[164:167], v8 offset:32768
    ds_read_b64_tr_b16 v[52:53], v11 offset:18432
    ds_read_b64_tr_b16 v[54:55], v11 offset:18944
    v_mfma_f32_32x32x16_bf16 v[64:79], v[60:63], v[156:159], v[64:79]
    ds_read_b128 v[168:171], v9 offset:32768
    ds_read_b64_tr_b16 v[56:57], v11 offset:20480
    ds_read_b64_tr_b16 v[58:59], v11 offset:20992
    ds_read_b128 v[172:175], v10 offset:32768
    ds_read_b64_tr_b16 v[60:61], v11 offset:22528
    ds_read_b64_tr_b16 v[62:63], v11 offset:23040
    s_mul_i32 s65, s40, 42
    s_add_u32 m0, s60, 7296
    s_add_u32 s65, s65, s59
    buffer_load_dwordx4 v6, s[12:15], s65 offen offset:896 lds
    s_lshr_b32 s64, s40, 5
    s_add_u32 m0, s61, 73728
    s_add_u32 s64, s64, s58
    buffer_load_dwordx4 v2, s[8:11], s64 offen lds
    buffer_load_dwordx4 v3, s[8:11], s64 offen offset:1024 lds
    s_cmp_lt_u32 s32, 6
    s_cbranch_scc1 L_x30
    s_cmp_eq_u32 s32, 6
    s_cbranch_scc1 L_x50
    s_mul_i32 s64, s3, 32
    s_add_u32 s64, s64, 65536
    v_mov_b32 v36, s98
    s_mov_b64 exec, 1
    buffer_store_dword v36, v13, s[20:23], s64 offen sc1
    s_mov_b64 exec, -1
    s_branch L_x30
L_x50:
    buffer_load_dword v28, v26, s[20:23], s100 offen
L_x30:
    s_and_b32 s48, s34, 12
    s_lshl_b32 s48, s48, 11
    s_add_u32 s46, s68, s48
    s_add_u32 s46, s46, s49
    s_add_u32 s68, s68, s5
    v_and_b32 v44, 31, v1
    v_lshrrev_b32 v45, 5, v1
    v_bfe_u32 v46, v1, 1, 3
    s_waitcnt lgkmcnt(9)
    v_mfma_f32_32x32x16_bf16 v[64:79], v[48:51], v[160:163], v[64:79]
    v_xor_b32 v45, v45, v46
    v_mul_u32_u24 v44, 192, v44
    v_lshl_add_u32 v44, v45, 3, v44
    s_mul_i32 s48, s32, 6144
    s_add_u32 s48, s48, 114688
    v_add_u32 v248, s48, v44
    v_xor_b32 v249, 16, v248
    v_xor_b32 v250, 32, v248
    s_waitcnt lgkmcnt(6)
    v_mfma_f32_32x32x16_bf16 v[64:79], v[52:55], v[164:167], v[64:79]
    v_xor_b32 v251, 48, v248
    v_lshrrev_b32 v44, 4, v1
    v_bfe_u32 v45, v1, 2, 2
    v_lshl_add_u32 v44, v44, 3, v45
    v_bfe_u32 v45, v44, 1, 3
    v_and_b32 v46, 3, v1
    v_xor_b32 v45, v45, v46
    v_mul_u32_u24 v44, 192, v44
    s_waitcnt lgkmcnt(0)
    v_mfma_f32_32x32x16_bf16 v[64:79], v[56:59], v[168:171], v[64:79]
    s_waitcnt vmcnt(3)
    s_barrier
    ds_read_b128 v[176:179], v7 offset:0
    ds_read_b64_tr_b16 v[48:49], v11 offset:0
    ds_read_b64_tr_b16 v[50:51], v11 offset:512
    ds_read_b128 v[180:183], v8 offset:0
    ds_read_b64_tr_b16 v[52:53], v11 offset:2048
    ds_read_b64_tr_b16 v[54:55], v11 offset:2560
    v_mfma_f32_32x32x16_bf16 v[64:79], v[60:63], v[172:175], v[64:79]
    ds_read_b128 v[184:187], v9 offset:0
    ds_read_b64_tr_b16 v[56:57], v11 offset:4096
    ds_read_b64_tr_b16 v[58:59], v11 offset:4608
    ds_read_b128 v[188:191], v10 offset:0
    ds_read_b64_tr_b16 v[60:61], v11 offset:6144
    ds_read_b64_tr_b16 v[62:63], v11 offset:6656
    s_mul_i32 s65, s41, 42
    s_add_u32 m0, s60, 15488
    s_add_u32 s65, s65, s59
    buffer_load_dwordx4 v6, s[12:15], s65 offen offset:896 lds
    s_lshr_b32 s64, s41, 5
    s_add_u32 m0, s61, 90112
    s_add_u32 s64, s64, s58
    buffer_load_dwordx4 v2, s[8:11], s64 offen lds
    buffer_load_dwordx4 v3, s[8:11], s64 offen offset:1024 lds
    v_lshl_add_u32 v44, v45, 3, v44
    s_and_b32 s78, s32, 1
    s_bfe_u32 s79, s32, 0x10001
    s_mul_i32 s49, s52, 24576
    s_add_u32 s49, s49, 114688
    v_add_u32 v44, s49, v44
    s_and_b32 s48, s78, 1
    s_lshl_b32 s48, s48, 5
    s_waitcnt lgkmcnt(9)
    v_mfma_f32_32x32x16_bf16 v[64:79], v[48:51], v[176:179], v[64:79]
    v_xor_b32 v45, s48, v44
    s_lshr_b32 s48, s78, 1
    s_lshl_b32 s48, s48, 6
    v_add_u32 v29, s48, v45
    v_xor_b32 v30, 16, v29
    s_lshl_b32 s48, s79, 5
    v_xor_b32 v252, s48, v44
    v_xor_b32 v253, 16, v252
    s_waitcnt lgkmcnt(6)
    v_mfma_f32_32x32x16_bf16 v[64:79], v[52:55], v[180:183], v[64:79]
    v_xor_b32 v254, 32, v252
    v_xor_b32 v255, 48, v252
    v_and_b32 v44, 7, v1
    v_and_b32 v45, 3, v1
    s_and_b32 s48, s34, 12
    v_add_u32 v45, s48, v45
    v_lshlrev_b32 v45, 3, v45
    v_add_u32 v45, s33, v45
    s_waitcnt lgkmcnt(0)
    v_mfma_f32_32x32x16_bf16 v[64:79], v[56:59], v[184:187], v[64:79]
    s_waitcnt vmcnt(3)
    s_barrier
    ds_read_b128 v[192:195], v7 offset:16384
    ds_read_b64_tr_b16 v[48:49], v11 offset:8192
    ds_read_b64_tr_b16 v[50:51], v11 offset:8704
    ds_read_b128 v[196:199], v8 offset:16384
    ds_read_b64_tr_b16 v[52:53], v11 offset:10240
    ds_read_b64_tr_b16 v[54:55], v11 offset:10752
    v_mfma_f32_32x32x16_bf16 v[64:79], v[60:63], v[188:191], v[64:79]
    ds_read_b128 v[200:203], v9 offset:16384
    ds_read_b64_tr_b16 v[56:57], v11 offset:12288
    ds_read_b64_tr_b16 v[58:59], v11 offset:12800
    ds_read_b128 v[204:207], v10 offset:16384
    ds_read_b64_tr_b16 v[60:61], v11 offset:14336
    ds_read_b64_tr_b16 v[62:63], v11 offset:14848
    s_mul_i32 s65, s42, 42
    s_add_u32 m0, s60, -896
    s_add_u32 s65, s65, s59
    buffer_load_dwordx4 v6, s[12:15], s65 offen offset:896 lds
    s_lshr_b32 s64, s42, 5
    s_add_u32 m0, s61, 57344
    s_add_u32 s64, s64, s58
    buffer_load_dwordx4 v2, s[8:11], s64 offen lds
    buffer_load_dwordx4 v3, s[8:11], s64 offen offset:1024 lds
    s_lshl_b32 s48, s34, 3
    v_add_u32 v44, s48, v44
    v_cmp_gt_u32 vcc, 8, v1
    s_mov_b32 s6, 0x3f80
    s_mov_b32 s7, 0x3f800000
    v_cndmask_b32 v44, v45, v44, vcc
    v_mul_u32_u24 v5, 32, v44
    v_mov_b32 v96, s74
    v_mov_b32 v97, s74
    v_mov_b32 v98, s74
    v_mov_b32 v99, s74
    v_mov_b32 v100, s74
    v_mov_b32 v101, s74
    v_mov_b32 v102, s74
    v_mov_b32 v103, s74
    v_mov_b32 v104, s74
    v_mov_b32 v105, s74
    v_mov_b32 v106, s74
    v_mov_b32 v107, s74
    v_mov_b32 v108, s74
    v_mov_b32 v109, s74
    v_mov_b32 v110, s74
    v_mov_b32 v111, s74
    s_cmp_ge_u32 s33, 6
    s_cselect_b32 s48, 1, 0
    s_xor_b32 s4, s33, s48
    s_mul_i32 s55, s33, 14
    s_add_u32 s55, s55, s32
    s_mul_i32 s55, s55, 3584
    v_lshrrev_b32 v44, 4, v1
    v_lshlrev_b32 v45, 2, v44
    v_sub_u32 v45, v1, v45
    s_and_b32 s48, s4, 3
    s_cmp_eq_u32 s48, 3
    s_cselect_b32 s49, 7, 15
    v_and_b32 v45, s49, v45
    v_mul_u32_u24 v44, 896, v44
    v_lshl_add_u32 v44, v45, 4, v44
    s_lshl_b32 s48, s48, 8
    v_add_u32 v17, s48, v44
    s_mov_b32 s48, 155648
    s_cmp_lt_u32 s32, 2
    s_cselect_b32 s43, s48, 63488
    s_add_u32 s43, s43, s5
    s_waitcnt lgkmcnt(9)
    v_mfma_f32_32x32x16_bf16 v[64:79], v[48:51], v[192:195], v[64:79]
    v_lshrrev_b32 v44, 5, v1
    v_bfe_u32 v45, v1, 2, 2
    v_mad_u32_u24 v46, v44, 7, v45
    v_bfe_u32 v44, v1, 4, 1
    v_and_b32 v45, 3, v1
    v_lshl_add_u32 v45, v44, 2, v45
    v_lshlrev_b32 v45, 3, v45
    s_lshl_b32 s48, s53, 6
    s_waitcnt lgkmcnt(6)
    v_mfma_f32_32x32x16_bf16 v[64:79], v[52:55], v[196:199], v[64:79]
    v_add_u32 v47, 0, v46
    v_lshlrev_b32 v44, 6, v47
    v_add3_u32 v44, v44, v45, s48
    v_and_b32 v44, 255, v44
    v_lshl_add_u32 v18, v47, 8, v44
    v_add_u32 v20, 114688, v18
    v_add_u32 v22, 65536, v18
    v_add_u32 v47, 14, v46
    s_waitcnt lgkmcnt(0)
    v_mfma_f32_32x32x16_bf16 v[64:79], v[56:59], v[200:203], v[64:79]
    s_waitcnt vmcnt(3)
    s_barrier
    ds_read_b128 v[208:211], v7 offset:32768
    ds_read_b64_tr_b16 v[48:49], v11 offset:16384
    ds_read_b64_tr_b16 v[50:51], v11 offset:16896
    ds_read_b128 v[212:215], v8 offset:32768
    ds_read_b64_tr_b16 v[52:53], v11 offset:18432
    ds_read_b64_tr_b16 v[54:55], v11 offset:18944
    v_mfma_f32_32x32x16_bf16 v[64:79], v[60:63], v[204:207], v[64:79]
    ds_read_b128 v[216:219], v9 offset:32768
    ds_read_b64_tr_b16 v[56:57], v11 offset:20480
    ds_read_b64_tr_b16 v[58:59], v11 offset:20992
    ds_read_b128 v[220:223], v10 offset:32768
    ds_read_b64_tr_b16 v[60:61], v11 offset:22528
    ds_read_b64_tr_b16 v[62:63], v11 offset:23040
    s_mul_i32 s65, s36, 42
    s_add_u32 m0, s5, 0
    s_add_u32 s65, s65, s59
    s_add_u32 s65, s65, 1792
    buffer_load_dwordx4 v6, s[12:15], s65 offen lds
    s_mul_i32 s65, s37, 42
    s_add_u32 m0, s5, 8192
    s_add_u32 s65, s65, s59
    s_add_u32 s65, s65, 1792
    buffer_load_dwordx4 v6, s[12:15], s65 offen lds
    v_lshlrev_b32 v44, 6, v47
    v_add3_u32 v44, v44, v45, s48
    v_and_b32 v44, 255, v44
    v_lshl_add_u32 v19, v47, 8, v44
    v_add_u32 v21, 114688, v19
    v_add_u32 v23, 65536, v19
    s_mul_i32 s49, s52, 4608
    s_add_u32 s49, s49, 81920
    s_waitcnt lgkmcnt(9)
    v_mfma_f32_32x32x16_bf16 v[64:79], v[48:51], v[208:211], v[64:79]
    v_and_b32 v45, 15, v1
    s_lshl_b32 s48, s79, 4
    v_add_u32 v45, s48, v45
    v_bfe_u32 v46, v1, 4, 1
    v_lshrrev_b32 v44, 5, v1
    v_lshlrev_b32 v44, 3, v44
    v_lshl_add_u32 v44, v46, 4, v44
    v_mul_u32_u24 v45, 144, v45
    s_waitcnt lgkmcnt(6)
    v_mfma_f32_32x32x16_bf16 v[64:79], v[52:55], v[212:215], v[64:79]
    s_lshl_b32 s48, s78, 5
    s_add_u32 s48, s48, s49
    v_add3_u32 v24, v45, v44, s48
    v_and_b32 v44, 3, v1
    v_bfe_u32 v45, v1, 3, 1
    v_lshl_add_u32 v44, v45, 2, v44
    v_bfe_u32 v45, v1, 4, 1
    v_bfe_u32 v46, v1, 2, 1
    s_waitcnt lgkmcnt(0)
    v_mfma_f32_32x32x16_bf16 v[64:79], v[56:59], v[216:219], v[64:79]
    s_waitcnt vmcnt(2)
    s_barrier
    ds_read_b128 v[224:227], v7 offset:0
    ds_read_b64_tr_b16 v[48:49], v11 offset:0
    ds_read_b64_tr_b16 v[50:51], v11 offset:512
    ds_read_b128 v[228:231], v8 offset:0
    ds_read_b64_tr_b16 v[52:53], v11 offset:2048
    ds_read_b64_tr_b16 v[54:55], v11 offset:2560
    v_mfma_f32_32x32x16_bf16 v[64:79], v[60:63], v[220:223], v[64:79]
    ds_read_b128 v[232:235], v9 offset:0
    ds_read_b64_tr_b16 v[56:57], v11 offset:4096
    ds_read_b64_tr_b16 v[58:59], v11 offset:4608
    ds_read_b128 v[236:239], v10 offset:0
    ds_read_b64_tr_b16 v[60:61], v11 offset:6144
    ds_read_b64_tr_b16 v[62:63], v11 offset:6656
    s_mul_i32 s65, s38, 42
    s_add_u32 m0, s5, 16384
    s_add_u32 s65, s65, s59
    s_add_u32 s65, s65, 1792
    buffer_load_dwordx4 v6, s[12:15], s65 offen lds
    s_mul_i32 s65, s39, 42
    s_add_u32 m0, s5, 24576
    s_add_u32 s65, s65, s59
    s_add_u32 s65, s65, 1792
    buffer_load_dwordx4 v6, s[12:15], s65 offen lds
    v_lshl_add_u32 v45, v45, 1, v46
    v_mad_u32_u24 v45, v45, 7, v44
    v_cmp_eq_u32 s[50:51], 7, v44
    v_lshrrev_b32 v46, 5, v1
    v_lshlrev_b32 v46, 4, v46
    v_cndmask_b32_e64 v45, v45, 28, s[50:51]
    v_mul_u32_u24 v45, 144, v45
    v_add3_u32 v25, v45, v46, s49
    s_lshl_b32 s49, s52, 15
    v_add_u32 v4, s49, v13
    s_lshl_b32 s48, s53, 10
    s_add_u32 s48, s48, 4096
    s_add_u32 s63, s48, s49
    v_add_u32 v15, s63, v13
    s_lshl_b32 s28, s33, 12
    s_add_u32 s28, s28, s48
    s_lshr_b32 s48, s4, 2
    s_lshl_b32 s48, s48, 16
    s_add_u32 s62, s49, s48
    s_add_u32 s62, s62, s69
    s_and_b32 s48, s53, 1
    s_lshl_b32 s48, s48, 15
    s_lshl_b32 s49, s52, 11
    s_add_u32 s48, s48, s49
    v_add_u32 v27, s48, v13
    v_lshrrev_b32 v44, 4, v1
    s_lshl_b32 s48, s78, 2
    v_add_u32 v44, s48, v44
    v_cmp_eq_u32 s[50:51], 7, v44
    s_waitcnt lgkmcnt(9)
    v_mfma_f32_32x32x16_bf16 v[64:79], v[48:51], v[224:227], v[64:79]
    s_waitcnt lgkmcnt(6)
    v_mfma_f32_32x32x16_bf16 v[64:79], v[52:55], v[228:231], v[64:79]
    s_waitcnt lgkmcnt(0)
    v_mfma_f32_32x32x16_bf16 v[64:79], v[56:59], v[232:235], v[64:79]
    s_waitcnt vmcnt(2)
    s_barrier
    v_mfma_f32_32x32x16_bf16 v[64:79], v[60:63], v[236:239], v[64:79]
    s_mul_i32 s65, s40, 42
    s_add_u32 m0, s5, 32768
    s_add_u32 s65, s65, s59
    s_add_u32 s65, s65, 1792
    buffer_load_dwordx4 v6, s[12:15], s65 offen lds
    ds_read_b64_tr_b16 v[48:49], v16 offset:0
    ds_read_b64_tr_b16 v[50:51], v16 offset:512
    ds_read_b64_tr_b16 v[52:53], v16 offset:2048
    ds_read_b64_tr_b16 v[54:55], v16 offset:2560
    ds_read_b64_tr_b16 v[56:57], v16 offset:4096
    ds_read_b64_tr_b16 v[58:59], v16 offset:4608
    s_waitcnt lgkmcnt(4)
    v_mfma_f32_32x32x16_bf16 v[80:95], v[48:51], v[128:131], 0
    ds_read_b64_tr_b16 v[60:61], v16 offset:6144
    ds_read_b64_tr_b16 v[62:63], v16 offset:6656
    s_mov_b32 s64, 65536
    s_mov_b64 exec, 0xfff
    buffer_load_dword v14, v5, s[20:23], s64 offen sc1
    s_mov_b64 exec, -1
    s_mul_i32 s65, s41, 42
    s_add_u32 m0, s5, 40960
    s_add_u32 s65, s65, s59
    s_add_u32 s65, s65, 1792
    buffer_load_dwordx4 v6, s[12:15], s65 offen lds
    v_mul_f32 v112, s72, v64
    v_mul_f32 v113, s72, v65
    v_mul_f32 v114, s72, v66
    v_mul_f32 v115, s72, v67
    s_waitcnt lgkmcnt(4)
    v_mfma_f32_32x32x16_bf16 v[80:95], v[52:55], v[132:135], v[80:95]
    ds_read_b64_tr_b16 v[48:49], v16 offset:8192
    ds_read_b64_tr_b16 v[50:51], v16 offset:8704
    v_mul_f32 v116, s72, v68
    v_mul_f32 v117, s72, v69
    v_mul_f32 v118, s72, v70
    s_waitcnt lgkmcnt(4)
    v_mfma_f32_32x32x16_bf16 v[80:95], v[56:59], v[136:139], v[80:95]
    ds_read_b64_tr_b16 v[52:53], v16 offset:10240
    ds_read_b64_tr_b16 v[54:55], v16 offset:10752
    s_mul_i32 s65, s42, 42
    s_add_u32 m0, s5, 49152
    s_add_u32 s65, s65, s59
    s_add_u32 s65, s65, 1792
    buffer_load_dwordx4 v6, s[12:15], s65 offen lds
    v_mul_f32 v119, s72, v71
    v_mul_f32 v120, s72, v72
    v_mul_f32 v121, s72, v73
    s_waitcnt lgkmcnt(4)
    v_mfma_f32_32x32x16_bf16 v[80:95], v[60:63], v[140:143], v[80:95]
    ds_read_b64_tr_b16 v[56:57], v16 offset:12288
    ds_read_b64_tr_b16 v[58:59], v16 offset:12800
    v_mul_f32 v122, s72, v74
    v_mul_f32 v123, s72, v75
    v_mul_f32 v124, s72, v76
    s_waitcnt lgkmcnt(4)
    v_mfma_f32_32x32x16_bf16 v[80:95], v[48:51], v[144:147], v[80:95]
    s_waitcnt vmcnt(4)
    s_barrier
    ds_read_b64_tr_b16 v[60:61], v16 offset:14336
    ds_read_b64_tr_b16 v[62:63], v16 offset:14848
    v_mul_f32 v125, s72, v77
    v_mul_f32 v126, s72, v78
    v_mul_f32 v127, s72, v79
    s_waitcnt lgkmcnt(4)
    v_mfma_f32_32x32x16_bf16 v[80:95], v[52:55], v[148:151], v[80:95]
    ds_read_b64_tr_b16 v[48:49], v16 offset:16384
    ds_read_b64_tr_b16 v[50:51], v16 offset:16896
    v_exp_f32 v112, v112 clamp
    v_exp_f32 v113, v113 clamp
    s_waitcnt lgkmcnt(4)
    v_mfma_f32_32x32x16_bf16 v[80:95], v[56:59], v[152:155], v[80:95]
    ds_read_b64_tr_b16 v[52:53], v16 offset:18432
    ds_read_b64_tr_b16 v[54:55], v16 offset:18944
    s_add_u32 m0, s5, 57344
    s_mul_i32 s65, s36, 42
    s_add_u32 s65, s65, s59
    buffer_load_dwordx4 v6, s[12:15], s65 offen lds
    v_exp_f32 v114, v114 clamp
    s_waitcnt lgkmcnt(4)
    v_mfma_f32_32x32x16_bf16 v[80:95], v[60:63], v[156:159], v[80:95]
    ds_read_b64_tr_b16 v[56:57], v16 offset:20480
    ds_read_b64_tr_b16 v[58:59], v16 offset:20992
    v_exp_f32 v115, v115 clamp
    v_exp_f32 v116, v116 clamp
    s_waitcnt lgkmcnt(4)
    v_mfma_f32_32x32x16_bf16 v[80:95], v[48:51], v[160:163], v[80:95]
    ds_read_b64_tr_b16 v[60:61], v16 offset:22528
    ds_read_b64_tr_b16 v[62:63], v16 offset:23040
    v_exp_f32 v117, v117 clamp
    s_waitcnt lgkmcnt(4)
    v_mfma_f32_32x32x16_bf16 v[80:95], v[52:55], v[164:167], v[80:95]
    ds_read_b64_tr_b16 v[48:49], v16 offset:24576
    ds_read_b64_tr_b16 v[50:51], v16 offset:25088
    s_add_u32 m0, s5, 65536
    s_mul_i32 s65, s37, 42
    s_add_u32 s65, s65, s59
    buffer_load_dwordx4 v6, s[12:15], s65 offen lds
    v_exp_f32 v118, v118 clamp
    v_exp_f32 v119, v119 clamp
    s_waitcnt lgkmcnt(4)
    v_mfma_f32_32x32x16_bf16 v[80:95], v[56:59], v[168:171], v[80:95]
    ds_read_b64_tr_b16 v[52:53], v16 offset:26624
    ds_read_b64_tr_b16 v[54:55], v16 offset:27136
    v_exp_f32 v120, v120 clamp
    v_exp_f32 v121, v121 clamp
    s_waitcnt lgkmcnt(4)
    v_mfma_f32_32x32x16_bf16 v[80:95], v[60:63], v[172:175], v[80:95]
    ds_read_b64_tr_b16 v[56:57], v16 offset:28672
    ds_read_b64_tr_b16 v[58:59], v16 offset:29184
    v_exp_f32 v122, v122 clamp
    s_waitcnt lgkmcnt(4)
    v_mfma_f32_32x32x16_bf16 v[80:95], v[48:51], v[176:179], v[80:95]
    s_waitcnt vmcnt(3)
    s_barrier
    ds_read_b64_tr_b16 v[60:61], v16 offset:30720
    ds_read_b64_tr_b16 v[62:63], v16 offset:31232
    s_add_u32 m0, s5, 73728
    s_mul_i32 s65, s38, 42
    s_add_u32 s65, s65, s59
    buffer_load_dwordx4 v6, s[12:15], s65 offen lds
    v_exp_f32 v123, v123 clamp
    v_exp_f32 v124, v124 clamp
    s_waitcnt lgkmcnt(4)
    v_mfma_f32_32x32x16_bf16 v[80:95], v[52:55], v[180:183], v[80:95]
    ds_read_b64_tr_b16 v[48:49], v16 offset:32768
    ds_read_b64_tr_b16 v[50:51], v16 offset:33280
    v_exp_f32 v125, v125 clamp
    s_waitcnt lgkmcnt(4)
    v_mfma_f32_32x32x16_bf16 v[80:95], v[56:59], v[184:187], v[80:95]
    ds_read_b64_tr_b16 v[52:53], v16 offset:34816
    ds_read_b64_tr_b16 v[54:55], v16 offset:35328
    v_exp_f32 v126, v126 clamp
    v_exp_f32 v127, v127 clamp
    s_waitcnt lgkmcnt(4)
    v_mfma_f32_32x32x16_bf16 v[80:95], v[60:63], v[188:191], v[80:95]
    ds_read_b64_tr_b16 v[56:57], v16 offset:36864
    ds_read_b64_tr_b16 v[58:59], v16 offset:37376
    s_add_u32 m0, s5, 81920
    s_mul_i32 s65, s39, 42
    s_add_u32 s65, s65, s59
    buffer_load_dwordx4 v6, s[12:15], s65 offen lds
    v_max_f32 v64, s74, v64
    v_max_f32 v65, s74, v65
    s_waitcnt lgkmcnt(4)
    v_mfma_f32_32x32x16_bf16 v[80:95], v[48:51], v[192:195], v[80:95]
    ds_read_b64_tr_b16 v[60:61], v16 offset:38912
    ds_read_b64_tr_b16 v[62:63], v16 offset:39424
    v_max_f32 v66, s74, v66
    v_max_f32 v67, s74, v67
    v_max_f32 v68, s74, v68
    s_waitcnt lgkmcnt(4)
    v_mfma_f32_32x32x16_bf16 v[80:95], v[52:55], v[196:199], v[80:95]
    ds_read_b64_tr_b16 v[48:49], v16 offset:40960
    ds_read_b64_tr_b16 v[50:51], v16 offset:41472
    v_max_f32 v69, s74, v69
    v_max_f32 v70, s74, v70
    v_max_f32 v71, s74, v71
    s_waitcnt lgkmcnt(4)
    v_mfma_f32_32x32x16_bf16 v[80:95], v[56:59], v[200:203], v[80:95]
    ds_read_b64_tr_b16 v[52:53], v16 offset:43008
    ds_read_b64_tr_b16 v[54:55], v16 offset:43520
    s_add_u32 m0, s5, 90112
    s_mul_i32 s65, s40, 42
    s_add_u32 s65, s65, s59
    buffer_load_dwordx4 v6, s[12:15], s65 offen lds
    v_max_f32 v72, s74, v72
    v_max_f32 v73, s74, v73
    v_max_f32 v74, s74, v74
    v_max_f32 v75, s74, v75
    s_waitcnt lgkmcnt(4)
    v_mfma_f32_32x32x16_bf16 v[80:95], v[60:63], v[204:207], v[80:95]
    ds_read_b64_tr_b16 v[56:57], v16 offset:45056
    ds_read_b64_tr_b16 v[58:59], v16 offset:45568
    v_max_f32 v76, s74, v76
    v_max_f32 v77, s74, v77
    v_max_f32 v78, s74, v78
    s_waitcnt lgkmcnt(4)
    v_mfma_f32_32x32x16_bf16 v[80:95], v[48:51], v[208:211], v[80:95]
    s_waitcnt vmcnt(5)
    s_barrier
    ds_read_b64_tr_b16 v[60:61], v16 offset:47104
    ds_read_b64_tr_b16 v[62:63], v16 offset:47616
    v_max_f32 v79, s74, v79
    v_add_f32 v64, v64, v112
    v_add_f32 v65, v65, v113
    s_waitcnt lgkmcnt(4)
    v_mfma_f32_32x32x16_bf16 v[80:95], v[52:55], v[212:215], v[80:95]
    ds_read_b64_tr_b16 v[48:49], v16 offset:49152
    ds_read_b64_tr_b16 v[50:51], v16 offset:49664
    s_add_u32 m0, s5, 98304
    s_mul_i32 s65, s41, 42
    s_add_u32 s65, s65, s59
    buffer_load_dwordx4 v6, s[12:15], s65 offen lds
    v_add_f32 v66, v66, v114
    v_add_f32 v67, v67, v115
    v_cvt_pk_bf16_f32 v40, v64, v65
    s_waitcnt lgkmcnt(4)
    v_mfma_f32_32x32x16_bf16 v[80:95], v[56:59], v[216:219], v[80:95]
    ds_read_b64_tr_b16 v[52:53], v16 offset:51200
    ds_read_b64_tr_b16 v[54:55], v16 offset:51712
    v_cvt_pk_bf16_f32 v41, v66, v67
    ds_write_b64 v248, v[40:41] offset:0
    v_add_f32 v68, v68, v116
    v_add_f32 v69, v69, v117
    s_waitcnt lgkmcnt(5)
    v_mfma_f32_32x32x16_bf16 v[80:95], v[60:63], v[220:223], v[80:95]
    ds_read_b64_tr_b16 v[56:57], v16 offset:53248
    ds_read_b64_tr_b16 v[58:59], v16 offset:53760
    v_add_f32 v70, v70, v118
    v_add_f32 v71, v71, v119
    v_cvt_pk_bf16_f32 v42, v68, v69
    s_waitcnt lgkmcnt(5)
    v_mfma_f32_32x32x16_bf16 v[80:95], v[48:51], v[224:227], v[80:95]
    ds_read_b64_tr_b16 v[60:61], v16 offset:55296
    ds_read_b64_tr_b16 v[62:63], v16 offset:55808
    s_add_u32 m0, s5, 106496
    s_mul_i32 s65, s42, 42
    s_add_u32 s65, s65, s59
    buffer_load_dwordx4 v6, s[12:15], s65 offen lds
    v_cvt_pk_bf16_f32 v43, v70, v71
    ds_write_b64 v249, v[42:43] offset:0
    v_add_f32 v72, v72, v120
    v_add_f32 v73, v73, v121
    s_waitcnt lgkmcnt(6)
    v_mfma_f32_32x32x16_bf16 v[80:95], v[52:55], v[228:231], v[80:95]
    v_add_f32 v74, v74, v122
    v_add_f32 v75, v75, v123
    v_cvt_pk_bf16_f32 v44, v72, v73
    s_waitcnt lgkmcnt(3)
    v_mfma_f32_32x32x16_bf16 v[80:95], v[56:59], v[232:235], v[80:95]
    s_cmp_lg_u32 s32, 6
    s_cbranch_scc1 L_x20
    buffer_load_dword v7, v26, s[20:23], s100 offen offset:1024
L_x20:
    s_and_b32 s64, s32, 6
    s_cmp_lg_u32 s64, 4
    s_cbranch_scc1 L_wt0
    v_and_b32 v2, 127, v0
    v_min_u32 v2, 97, v2
    v_lshlrev_b32 v2, 7, v2
    s_mul_i32 s64, s75, 12544
    buffer_load_dword v7, v2, s[16:19], s64 offen
L_wt0:
    v_cvt_pk_bf16_f32 v45, v74, v75
    ds_write_b64 v250, v[44:45] offset:0
    v_add_f32 v76, v76, v124
    v_add_f32 v77, v77, v125
    s_waitcnt lgkmcnt(2)
    v_mfma_f32_32x32x16_bf16 v[80:95], v[60:63], v[236:239], v[80:95]
    v_add_f32 v78, v78, v126
    v_add_f32 v79, v79, v127
    v_cvt_pk_bf16_f32 v46, v76, v77
    v_cvt_pk_bf16_f32 v47, v78, v79
    ds_write_b64 v251, v[46:47] offset:0
    s_nop 6
    v_cndmask_b32 v92, v92, 1.0, s[70:71]
    v_cvt_pk_bf16_f32 v48, v80, v81
    v_cvt_pk_bf16_f32 v49, v82, v83
    ds_write_b64 v248, v[48:49] offset:128
    v_cvt_pk_bf16_f32 v50, v84, v85
    v_cvt_pk_bf16_f32 v51, v86, v87
    ds_write_b64 v249, v[50:51] offset:128
    v_cvt_pk_bf16_f32 v52, v88, v89
    v_cvt_pk_bf16_f32 v53, v90, v91
    ds_write_b64 v250, v[52:53] offset:128
    v_cvt_pk_bf16_f32 v54, v92, v93
    v_cvt_pk_bf16_f32 v55, v94, v95
    ds_write_b64 v251, v[54:55] offset:128
    v_mov_b32 v34, s47
    s_mov_b64 exec, 0xfff
    v_cmp_ne_u32 vcc, s98, v14
    s_mov_b64 exec, -1
    s_mov_b32 s64, s35
    s_and_b32 s65, vcc_lo, 0xff
    s_cselect_b32 s99, 0, 1
    s_and_b32 s65, vcc_lo, 0xf00
    s_cselect_b32 s54, 0, 1
    s_waitcnt lgkmcnt(0)
    s_barrier
    ds_read_b64_tr_b16 v[64:65], v29 offset:0
    ds_read_b64_tr_b16 v[66:67], v30 offset:768
    ds_read_b64_tr_b16 v[68:69], v252 offset:128
    ds_read_b64_tr_b16 v[70:71], v253 offset:896
    ds_read_b64_tr_b16 v[72:73], v29 offset:6144
    ds_read_b64_tr_b16 v[74:75], v30 offset:6912
    ds_read_b64_tr_b16 v[76:77], v252 offset:6272
    ds_read_b64_tr_b16 v[78:79], v253 offset:7040
    ds_read_b64_tr_b16 v[80:81], v29 offset:12288
    ds_read_b64_tr_b16 v[82:83], v30 offset:13056
    ds_read_b64_tr_b16 v[84:85], v252 offset:12416
    ds_read_b64_tr_b16 v[86:87], v253 offset:13184
    s_mul_i32 s66, s36, 7
    s_lshl1_add_u32 m0, s36, s5
    s_add_u32 s66, s66, s55
    s_sub_u32 s67, s66, 401408
    s_min_u32 s66, s66, s67
    buffer_load_dwordx4 v17, s[16:19], s66 offen lds
    s_mul_i32 s66, s37, 7
    s_lshl1_add_u32 m0, s37, s5
    s_add_u32 s66, s66, s55
    s_sub_u32 s67, s66, 401408
    s_min_u32 s66, s66, s67
    buffer_load_dwordx4 v17, s[16:19], s66 offen lds
    s_mov_b32 s65, 0xffff0000
    s_waitcnt lgkmcnt(8)
    v_mfma_f32_16x16x32_bf16 v[120:123], v[64:67], v[68:71], 0
    ds_read_b64_tr_b16 v[88:89], v29 offset:18432
    ds_read_b64_tr_b16 v[90:91], v30 offset:19200
    ds_read_b64_tr_b16 v[92:93], v252 offset:18560
    ds_read_b64_tr_b16 v[94:95], v253 offset:19328
    s_waitcnt lgkmcnt(8)
    v_mfma_f32_16x16x32_bf16 v[120:123], v[72:75], v[76:79], v[120:123]
    s_waitcnt lgkmcnt(4)
    v_mfma_f32_16x16x32_bf16 v[120:123], v[80:83], v[84:87], v[120:123]
    s_waitcnt lgkmcnt(0)
    v_mfma_f32_16x16x32_bf16 v[120:123], v[88:91], v[92:95], v[120:123]
    s_cmp_eq_u32 s54, 1
    s_nop 6
    v_cvt_pk_bf16_f32 v32, v120, v121
    v_cvt_pk_bf16_f32 v33, v122, v123
    v_lshl_or_b32 v120, v32, 16, v34
    v_and_or_b32 v121, v32, s65, v34
    v_lshl_or_b32 v122, v33, 16, v34
    v_and_or_b32 v123, v33, s65, v34
    s_cbranch_scc0 L_p1s0
    buffer_store_dwordx4 v[120:123], v13, s[20:23], s64 offen
L_p1j0:
    s_waitcnt vmcnt(3)
    s_barrier
    ds_read_b64_tr_b16 v[48:49], v12 offset:0
    ds_read_b64_tr_b16 v[50:51], v12 offset:512
    ds_read_b64_tr_b16 v[52:53], v12 offset:2048
    ds_read_b64_tr_b16 v[54:55], v12 offset:2560
    ds_read_b64_tr_b16 v[56:57], v12 offset:4096
    ds_read_b64_tr_b16 v[58:59], v12 offset:4608
    s_waitcnt lgkmcnt(4)
    v_mfma_f32_32x32x16_bf16 v[96:111], v[48:51], v[128:131], v[96:111]
    ds_read_b64_tr_b16 v[60:61], v12 offset:6144
    ds_read_b64_tr_b16 v[62:63], v12 offset:6656
    s_waitcnt lgkmcnt(4)
    v_mfma_f32_32x32x16_bf16 v[96:111], v[52:55], v[132:135], v[96:111]
    ds_read_b64_tr_b16 v[48:49], v12 offset:8192
    ds_read_b64_tr_b16 v[50:51], v12 offset:8704
    s_waitcnt lgkmcnt(4)
    v_mfma_f32_32x32x16_bf16 v[96:111], v[56:59], v[136:139], v[96:111]
    ds_read_b64_tr_b16 v[52:53], v12 offset:10240
    ds_read_b64_tr_b16 v[54:55], v12 offset:10752
    s_waitcnt lgkmcnt(4)
    v_mfma_f32_32x32x16_bf16 v[96:111], v[60:63], v[140:143], v[96:111]
    ds_read_b64_tr_b16 v[56:57], v12 offset:12288
    ds_read_b64_tr_b16 v[58:59], v12 offset:12800
    s_waitcnt lgkmcnt(4)
    v_mfma_f32_32x32x16_bf16 v[96:111], v[48:51], v[144:147], v[96:111]
    ds_read_b64_tr_b16 v[60:61], v12 offset:14336
    ds_read_b64_tr_b16 v[62:63], v12 offset:14848
    s_cmp_ge_u32 s32, 2
    s_cbranch_scc1 L_l1a0
    s_add_u32 s64, s45, 0
    buffer_load_dwordx4 v[64:67], v13, s[20:23], s64 offen sc1
    s_add_u32 s64, s45, 131072
    buffer_load_dwordx4 v[68:71], v13, s[20:23], s64 offen sc1
    s_add_u32 s64, s45, 262144
    buffer_load_dwordx4 v[72:75], v13, s[20:23], s64 offen sc1
    s_add_u32 s64, s45, 393216
    buffer_load_dwordx4 v[76:79], v13, s[20:23], s64 offen sc1
L_l1a0:
    s_waitcnt lgkmcnt(4)
    v_mfma_f32_32x32x16_bf16 v[96:111], v[52:55], v[148:151], v[96:111]
    ds_read_b64_tr_b16 v[48:49], v12 offset:16384
    ds_read_b64_tr_b16 v[50:51], v12 offset:16896
    s_waitcnt lgkmcnt(4)
    v_mfma_f32_32x32x16_bf16 v[96:111], v[56:59], v[152:155], v[96:111]
    ds_read_b64_tr_b16 v[52:53], v12 offset:18432
    ds_read_b64_tr_b16 v[54:55], v12 offset:18944
    s_waitcnt lgkmcnt(4)
    v_mfma_f32_32x32x16_bf16 v[96:111], v[60:63], v[156:159], v[96:111]
    ds_read_b64_tr_b16 v[56:57], v12 offset:20480
    ds_read_b64_tr_b16 v[58:59], v12 offset:20992
    s_cmp_ge_u32 s32, 2
    s_cbranch_scc1 L_l1b0
    v_mov_b32 v35, 0xffff0000
    s_mov_b32 s73, 0
L_g10:
    s_waitcnt vmcnt(3)
    v_xor_b32 v80, s47, v64
    v_xor_b32 v81, s47, v65
    v_xor_b32 v82, s47, v66
    v_xor_b32 v83, s47, v67
    v_or3_b32 v40, v80, v81, v82
    v_or_b32 v40, v40, v83
    s_waitcnt vmcnt(2)
    v_xor_b32 v68, s47, v68
    v_xor_b32 v69, s47, v69
    v_xor_b32 v70, s47, v70
    v_xor_b32 v71, s47, v71
    v_or3_b32 v40, v40, v68, v69
    v_or3_b32 v40, v40, v70, v71
    v_add_f32 v80, v80, v68
    v_add_f32 v81, v81, v69
    v_add_f32 v82, v82, v70
    v_add_f32 v83, v83, v71
    s_waitcnt vmcnt(1)
    v_xor_b32 v72, s47, v72
    v_xor_b32 v73, s47, v73
    v_xor_b32 v74, s47, v74
    v_xor_b32 v75, s47, v75
    v_or3_b32 v40, v40, v72, v73
    v_or3_b32 v40, v40, v74, v75
    v_add_f32 v80, v80, v72
    v_add_f32 v81, v81, v73
    v_add_f32 v82, v82, v74
    v_add_f32 v83, v83, v75
    s_waitcnt vmcnt(0)
    v_xor_b32 v76, s47, v76
    v_xor_b32 v77, s47, v77
    v_xor_b32 v78, s47, v78
    v_xor_b32 v79, s47, v79
    v_or3_b32 v40, v40, v76, v77
    v_or3_b32 v40, v40, v78, v79
    v_add_f32 v80, v80, v76
    v_add_f32 v81, v81, v77
    v_add_f32 v82, v82, v78
    v_add_f32 v83, v83, v79
    v_and_b32 v40, 0xffff, v40
    v_cmp_ne_u32 vcc, 0, v40
    s_cbranch_vccz L_g10x
    s_add_u32 s73, s73, 1
    s_cmp_ge_u32 s73, 100000
    s_cbranch_scc1 L_g10x
    s_add_u32 s64, s45, 0
    buffer_load_dwordx4 v[64:67], v13, s[20:23], s64 offen sc1
    s_add_u32 s64, s45, 131072
    buffer_load_dwordx4 v[68:71], v13, s[20:23], s64 offen sc1
    s_add_u32 s64, s45, 262144
    buffer_load_dwordx4 v[72:75], v13, s[20:23], s64 offen sc1
    s_add_u32 s64, s45, 393216
    buffer_load_dwordx4 v[76:79], v13, s[20:23], s64 offen sc1
    s_waitcnt vmcnt(0)
    s_branch L_g10
L_g10x:
    v_mov_b32 v34, s56
    s_mov_b32 s65, 0xffff0000
    v_cvt_pk_bf16_f32 v32, v80, v81
    v_cvt_pk_bf16_f32 v33, v82, v83
    v_lshl_or_b32 v112, v32, 16, v34
    v_and_or_b32 v113, v32, s65, v34
    v_lshl_or_b32 v114, v33, 16, v34
    v_and_or_b32 v115, v33, s65, v34
    buffer_store_dwordx4 v[112:115], v13, s[20:23], s46 offen sc1
L_l1b0:
    s_waitcnt lgkmcnt(4)
    v_mfma_f32_32x32x16_bf16 v[96:111], v[48:51], v[160:163], v[96:111]
    ds_read_b64_tr_b16 v[60:61], v12 offset:22528
    ds_read_b64_tr_b16 v[62:63], v12 offset:23040
    s_waitcnt lgkmcnt(4)
    v_mfma_f32_32x32x16_bf16 v[96:111], v[52:55], v[164:167], v[96:111]
    ds_read_b64_tr_b16 v[48:49], v12 offset:24576
    ds_read_b64_tr_b16 v[50:51], v12 offset:25088
    s_mul_i32 s66, s38, 7
    s_lshl1_add_u32 m0, s38, s5
    s_add_u32 s66, s66, s55
    s_sub_u32 s67, s66, 401408
    s_min_u32 s66, s66, s67
    buffer_load_dwordx4 v17, s[16:19], s66 offen lds
    s_waitcnt lgkmcnt(4)
    v_mfma_f32_32x32x16_bf16 v[96:111], v[56:59], v[168:171], v[96:111]
    ds_read_b64_tr_b16 v[52:53], v12 offset:26624
    ds_read_b64_tr_b16 v[54:55], v12 offset:27136
    s_waitcnt lgkmcnt(4)
    v_mfma_f32_32x32x16_bf16 v[96:111], v[60:63], v[172:175], v[96:111]
    ds_read_b64_tr_b16 v[56:57], v12 offset:28672
    ds_read_b64_tr_b16 v[58:59], v12 offset:29184
    s_mul_i32 s66, s39, 7
    s_lshl1_add_u32 m0, s39, s5
    s_add_u32 s66, s66, s55
    s_sub_u32 s67, s66, 401408
    s_min_u32 s66, s66, s67
    buffer_load_dwordx4 v17, s[16:19], s66 offen lds
    s_waitcnt lgkmcnt(4)
    v_mfma_f32_32x32x16_bf16 v[96:111], v[48:51], v[176:179], v[96:111]
    ds_read_b64_tr_b16 v[60:61], v12 offset:30720
    ds_read_b64_tr_b16 v[62:63], v12 offset:31232
    s_waitcnt lgkmcnt(4)
    v_mfma_f32_32x32x16_bf16 v[96:111], v[52:55], v[180:183], v[96:111]
    ds_read_b64_tr_b16 v[48:49], v12 offset:32768
    ds_read_b64_tr_b16 v[50:51], v12 offset:33280
    s_mul_i32 s66, s40, 7
    s_lshl1_add_u32 m0, s40, s5
    s_add_u32 s66, s66, s55
    s_sub_u32 s67, s66, 401408
    s_min_u32 s66, s66, s67
    buffer_load_dwordx4 v17, s[16:19], s66 offen lds
    s_waitcnt lgkmcnt(4)
    v_mfma_f32_32x32x16_bf16 v[96:111], v[56:59], v[184:187], v[96:111]
    ds_read_b64_tr_b16 v[52:53], v12 offset:34816
    ds_read_b64_tr_b16 v[54:55], v12 offset:35328
    s_waitcnt lgkmcnt(4)
    v_mfma_f32_32x32x16_bf16 v[96:111], v[60:63], v[188:191], v[96:111]
    ds_read_b64_tr_b16 v[56:57], v12 offset:36864
    ds_read_b64_tr_b16 v[58:59], v12 offset:37376
    s_mul_i32 s66, s41, 7
    s_lshl1_add_u32 m0, s41, s5
    s_add_u32 s66, s66, s55
    s_sub_u32 s67, s66, 401408
    s_min_u32 s66, s66, s67
    buffer_load_dwordx4 v17, s[16:19], s66 offen lds
    s_waitcnt lgkmcnt(4)
    v_mfma_f32_32x32x16_bf16 v[96:111], v[48:51], v[192:195], v[96:111]
    ds_read_b64_tr_b16 v[60:61], v12 offset:38912
    ds_read_b64_tr_b16 v[62:63], v12 offset:39424
    s_waitcnt lgkmcnt(4)
    v_mfma_f32_32x32x16_bf16 v[96:111], v[52:55], v[196:199], v[96:111]
    ds_read_b64_tr_b16 v[48:49], v12 offset:40960
    ds_read_b64_tr_b16 v[50:51], v12 offset:41472
    s_mul_i32 s66, s42, 7
    s_lshl1_add_u32 m0, s42, s5
    s_add_u32 s66, s66, s55
    s_sub_u32 s67, s66, 401408
    s_min_u32 s66, s66, s67
    buffer_load_dwordx4 v17, s[16:19], s66 offen lds
    s_waitcnt lgkmcnt(4)
    v_mfma_f32_32x32x16_bf16 v[96:111], v[56:59], v[200:203], v[96:111]
    ds_read_b64_tr_b16 v[52:53], v12 offset:43008
    ds_read_b64_tr_b16 v[54:55], v12 offset:43520
    s_waitcnt lgkmcnt(4)
    v_mfma_f32_32x32x16_bf16 v[96:111], v[60:63], v[204:207], v[96:111]
    ds_read_b64_tr_b16 v[56:57], v12 offset:45056
    ds_read_b64_tr_b16 v[58:59], v12 offset:45568
    s_waitcnt lgkmcnt(4)
    v_mfma_f32_32x32x16_bf16 v[96:111], v[48:51], v[208:211], v[96:111]
    ds_read_b64_tr_b16 v[60:61], v12 offset:47104
    ds_read_b64_tr_b16 v[62:63], v12 offset:47616
    s_waitcnt lgkmcnt(4)
    v_mfma_f32_32x32x16_bf16 v[96:111], v[52:55], v[212:215], v[96:111]
    ds_read_b64_tr_b16 v[48:49], v12 offset:49152
    ds_read_b64_tr_b16 v[50:51], v12 offset:49664
    s_add_u32 m0, s5, 114688
    s_add_u32 s66, s55, 200704
    s_sub_u32 s67, s66, 401408
    s_min_u32 s66, s66, s67
    buffer_load_dwordx4 v17, s[16:19], s66 offen lds
    s_waitcnt lgkmcnt(4)
    v_mfma_f32_32x32x16_bf16 v[96:111], v[56:59], v[216:219], v[96:111]
    ds_read_b64_tr_b16 v[52:53], v12 offset:51200
    ds_read_b64_tr_b16 v[54:55], v12 offset:51712
    s_waitcnt lgkmcnt(4)
    v_mfma_f32_32x32x16_bf16 v[96:111], v[60:63], v[220:223], v[96:111]
    ds_read_b64_tr_b16 v[56:57], v12 offset:53248
    ds_read_b64_tr_b16 v[58:59], v12 offset:53760
    s_waitcnt lgkmcnt(4)
    v_mfma_f32_32x32x16_bf16 v[96:111], v[48:51], v[224:227], v[96:111]
    ds_read_b64_tr_b16 v[60:61], v12 offset:55296
    ds_read_b64_tr_b16 v[62:63], v12 offset:55808
    s_add_u32 m0, s5, 122880
    s_add_u32 s66, s55, 229376
    s_sub_u32 s67, s66, 401408
    s_min_u32 s66, s66, s67
    buffer_load_dwordx4 v17, s[16:19], s66 offen lds
    s_waitcnt lgkmcnt(4)
    v_mfma_f32_32x32x16_bf16 v[96:111], v[52:55], v[228:231], v[96:111]
    s_waitcnt lgkmcnt(2)
    v_mfma_f32_32x32x16_bf16 v[96:111], v[56:59], v[232:235], v[96:111]
    s_waitcnt lgkmcnt(0)
    v_mfma_f32_32x32x16_bf16 v[96:111], v[60:63], v[236:239], v[96:111]
    s_waitcnt vmcnt(2)
    s_barrier
    ds_read_b64_tr_b16 v[128:129], v18 offset:0
    ds_read_b64_tr_b16 v[130:131], v18 offset:1024
    ds_read_b64_tr_b16 v[132:133], v19 offset:0
    ds_read_b64_tr_b16 v[134:135], v19 offset:1024
    ds_read_b64_tr_b16 v[136:137], v18 offset:7168
    ds_read_b64_tr_b16 v[138:139], v18 offset:8192
    ds_read_b64_tr_b16 v[140:141], v19 offset:7168
    ds_read_b64_tr_b16 v[142:143], v19 offset:8192
    ds_read_b64_tr_b16 v[144:145], v18 offset:14336
    ds_read_b64_tr_b16 v[146:147], v18 offset:15360
    ds_read_b64_tr_b16 v[148:149], v19 offset:14336
    ds_read_b64_tr_b16 v[150:151], v19 offset:15360
    s_waitcnt lgkmcnt(8)
    ds_read_b64_tr_b16 v[152:153], v18 offset:21504
    ds_read_b64_tr_b16 v[154:155], v18 offset:22528
    ds_read_b64_tr_b16 v[156:157], v19 offset:21504
    ds_read_b64_tr_b16 v[158:159], v19 offset:22528
    s_waitcnt lgkmcnt(8)
    ds_read_b64_tr_b16 v[160:161], v18 offset:28672
    ds_read_b64_tr_b16 v[162:163], v18 offset:29696
    ds_read_b64_tr_b16 v[164:165], v19 offset:28672
    ds_read_b64_tr_b16 v[166:167], v19 offset:29696
    v_pk_mul_f32 v[112:113], v[96:97], s[72:73] op_sel_hi:[1,0]
    v_pk_mul_f32 v[114:115], v[98:99], s[72:73] op_sel_hi:[1,0]
    v_pk_mul_f32 v[116:117], v[100:101], s[72:73] op_sel_hi:[1,0]
    v_pk_mul_f32 v[118:119], v[102:103], s[72:73] op_sel_hi:[1,0]
    v_pk_mul_f32 v[120:121], v[104:105], s[72:73] op_sel_hi:[1,0]
    v_pk_mul_f32 v[122:123], v[106:107], s[72:73] op_sel_hi:[1,0]
    v_pk_mul_f32 v[124:125], v[108:109], s[72:73] op_sel_hi:[1,0]
    v_pk_mul_f32 v[126:127], v[110:111], s[72:73] op_sel_hi:[1,0]
    v_exp_f32 v112, v112 clamp
    v_exp_f32 v113, v113 clamp
    v_exp_f32 v114, v114 clamp
    s_add_u32 s64, s68, 0
    buffer_load_dwordx4 v[64:67], v13, s[20:23], s64 offen sc1
    s_add_u32 s64, s68, 8192
    buffer_load_dwordx4 v[68:71], v13, s[20:23], s64 offen sc1
    v_exp_f32 v115, v115 clamp
    v_exp_f32 v116, v116 clamp
    v_exp_f32 v117, v117 clamp
    v_exp_f32 v118, v118 clamp
    v_exp_f32 v119, v119 clamp
    v_exp_f32 v120, v120 clamp
    s_add_u32 s64, s68, 16384
    buffer_load_dwordx4 v[72:75], v13, s[20:23], s64 offen sc1
    s_add_u32 s64, s68, 24576
    buffer_load_dwordx4 v[76:79], v13, s[20:23], s64 offen sc1
    v_exp_f32 v121, v121 clamp
    v_exp_f32 v122, v122 clamp
    v_exp_f32 v123, v123 clamp
    v_exp_f32 v124, v124 clamp
    v_exp_f32 v125, v125 clamp
    v_exp_f32 v126, v126 clamp
    v_exp_f32 v127, v127 clamp
    v_max_f32 v96, s74, v96
    v_max_f32 v97, s74, v97
    v_max_f32 v98, s74, v98
    s_add_u32 m0, s5, 131072
    s_add_u32 s66, s55, 258048
    s_sub_u32 s67, s66, 401408
    s_min_u32 s66, s66, s67
    buffer_load_dwordx4 v17, s[16:19], s66 offen lds
    v_max_f32 v99, s74, v99
    v_max_f32 v100, s74, v100
    v_max_f32 v101, s74, v101
    v_max_f32 v102, s74, v102
    v_max_f32 v103, s74, v103
    v_max_f32 v104, s74, v104
    s_waitcnt lgkmcnt(8)
    ds_read_b64_tr_b16 v[168:169], v18 offset:35840
    ds_read_b64_tr_b16 v[170:171], v18 offset:36864
    ds_read_b64_tr_b16 v[172:173], v19 offset:35840
    ds_read_b64_tr_b16 v[174:175], v19 offset:36864
    v_max_f32 v105, s74, v105
    v_max_f32 v106, s74, v106
    v_max_f32 v107, s74, v107
    v_max_f32 v108, s74, v108
    v_max_f32 v109, s74, v109
    s_waitcnt lgkmcnt(8)
    ds_read_b64_tr_b16 v[176:177], v18 offset:43008
    ds_read_b64_tr_b16 v[178:179], v18 offset:44032
    ds_read_b64_tr_b16 v[180:181], v19 offset:43008
    ds_read_b64_tr_b16 v[182:183], v19 offset:44032
    s_add_u32 m0, s5, 139264
    s_add_u32 s66, s55, 286720
    s_sub_u32 s67, s66, 401408
    s_min_u32 s66, s66, s67
    buffer_load_dwordx4 v17, s[16:19], s66 offen lds
    v_max_f32 v110, s74, v110
    v_max_f32 v111, s74, v111
    v_pk_add_f32 v[96:97], v[96:97], v[112:113]
    v_pk_add_f32 v[98:99], v[98:99], v[114:115]
    v_pk_add_f32 v[100:101], v[100:101], v[116:117]
    v_pk_add_f32 v[102:103], v[102:103], v[118:119]
    s_waitcnt lgkmcnt(8)
    ds_read_b64_tr_b16 v[184:185], v18 offset:50176
    ds_read_b64_tr_b16 v[186:187], v18 offset:51200
    ds_read_b64_tr_b16 v[188:189], v19 offset:50176
    ds_read_b64_tr_b16 v[190:191], v19 offset:51200
    v_pk_add_f32 v[104:105], v[104:105], v[120:121]
    v_pk_add_f32 v[106:107], v[106:107], v[122:123]
    v_pk_add_f32 v[108:109], v[108:109], v[124:125]
    v_pk_add_f32 v[110:111], v[110:111], v[126:127]
    v_cvt_pk_bf16_f32 v48, v96, v97
    s_add_u32 m0, s5, 147456
    s_add_u32 s66, s55, 315392
    s_sub_u32 s67, s66, 401408
    s_min_u32 s66, s66, s67
    buffer_load_dwordx4 v17, s[16:19], s66 offen lds
    v_cvt_pk_bf16_f32 v49, v98, v99
    v_cvt_pk_bf16_f32 v50, v100, v101
    v_cvt_pk_bf16_f32 v51, v102, v103
    v_cvt_pk_bf16_f32 v52, v104, v105
    v_cvt_pk_bf16_f32 v53, v106, v107
    v_cvt_pk_bf16_f32 v54, v108, v109
    v_cvt_pk_bf16_f32 v55, v110, v111
    s_mov_b32 s73, 0
L_g20:
    s_waitcnt vmcnt(6)
    v_xor_b32 v80, s56, v64
    v_xor_b32 v81, s56, v65
    v_xor_b32 v82, s56, v66
    v_xor_b32 v83, s56, v67
    v_or3_b32 v40, v80, v81, v82
    v_or_b32 v40, v40, v83
    s_waitcnt vmcnt(5)
    v_xor_b32 v68, s56, v68
    v_xor_b32 v69, s56, v69
    v_xor_b32 v70, s56, v70
    v_xor_b32 v71, s56, v71
    v_or3_b32 v40, v40, v68, v69
    v_or3_b32 v40, v40, v70, v71
    v_add_f32 v80, v80, v68
    v_add_f32 v81, v81, v69
    v_add_f32 v82, v82, v70
    v_add_f32 v83, v83, v71
    s_waitcnt vmcnt(4)
    v_xor_b32 v72, s56, v72
    v_xor_b32 v73, s56, v73
    v_xor_b32 v74, s56, v74
    v_xor_b32 v75, s56, v75
    v_or3_b32 v40, v40, v72, v73
    v_or3_b32 v40, v40, v74, v75
    v_add_f32 v80, v80, v72
    v_add_f32 v81, v81, v73
    v_add_f32 v82, v82, v74
    v_add_f32 v83, v83, v75
    s_waitcnt vmcnt(3)
    v_xor_b32 v76, s56, v76
    v_xor_b32 v77, s56, v77
    v_xor_b32 v78, s56, v78
    v_xor_b32 v79, s56, v79
    v_or3_b32 v40, v40, v76, v77
    v_or3_b32 v40, v40, v78, v79
    v_add_f32 v80, v80, v76
    v_add_f32 v81, v81, v77
    v_add_f32 v82, v82, v78
    v_add_f32 v83, v83, v79
    v_and_b32 v40, 0xffff, v40
    v_cmp_ne_u32 vcc, 0, v40
    s_cbranch_vccz L_g20x
    s_add_u32 s73, s73, 1
    s_cmp_ge_u32 s73, 100000
    s_cbranch_scc1 L_g20x
    s_add_u32 s64, s68, 0
    buffer_load_dwordx4 v[64:67], v13, s[20:23], s64 offen sc1
    s_add_u32 s64, s68, 8192
    buffer_load_dwordx4 v[68:71], v13, s[20:23], s64 offen sc1
    s_add_u32 s64, s68, 16384
    buffer_load_dwordx4 v[72:75], v13, s[20:23], s64 offen sc1
    s_add_u32 s64, s68, 24576
    buffer_load_dwordx4 v[76:79], v13, s[20:23], s64 offen sc1
    s_waitcnt vmcnt(0)
    s_branch L_g20
L_g20x:
    v_cvt_pk_bf16_f32 v64, v80, v81
    v_cvt_pk_bf16_f32 v65, v82, v83
    v_cndmask_b32_e64 v64, v64, 0, s[50:51]
    v_cndmask_b32_e64 v65, v65, 0, s[50:51]
    ds_write_b64 v24, v[64:65]
    v_mov_b32 v34, s57
    s_mov_b32 m0, s43
    s_add_u32 s66, s55, 344064
    s_sub_u32 s67, s66, 401408
    s_min_u32 s66, s66, s67
    buffer_load_dwordx4 v17, s[16:19], s66 offen lds
    s_waitcnt lgkmcnt(0)
    s_barrier
    ds_read_b128 v[64:67], v25 offset:0
    ds_read_b128 v[68:71], v25 offset:32
    s_add_u32 m0, s5, 71680
    s_add_u32 s66, s55, 372736
    s_sub_u32 s67, s66, 401408
    s_min_u32 s66, s66, s67
    buffer_load_dwordx4 v17, s[16:19], s66 offen lds
    s_waitcnt lgkmcnt(1)
    v_mfma_f32_32x32x16_bf16 v[96:111], v[64:67], v[48:51], 0
    s_waitcnt lgkmcnt(0)
    v_mfma_f32_32x32x16_bf16 v[96:111], v[68:71], v[52:55], v[96:111]
    s_nop 11
    v_add_f32 v32, s74, v103
    v_rcp_f32 v32, v32
    s_cmp_eq_u32 s99, 1
    v_mul_f32 v96, v32, v96
    v_mul_f32 v97, v32, v97
    v_mul_f32 v98, v32, v98
    v_mul_f32 v99, v32, v99
    v_mul_f32 v100, v32, v100
    v_mul_f32 v101, v32, v101
    v_mul_f32 v102, v32, v102
    v_cvt_pk_bf16_f32 v80, v96, v97
    v_cvt_pk_bf16_f32 v81, v98, v99
    v_cvt_pk_bf16_f32 v82, v100, v101
    v_cvt_pk_bf16_f32 v83, v102, v103
    v_and_or_b32 v83, v83, s96, v34
    s_cbranch_scc0 L_slow0_0
    buffer_store_dwordx4 v[80:83], v13, s[20:23], s35 offen offset:0
L_pub0_0:
    v_mul_f32 v104, v32, v104
    v_mul_f32 v105, v32, v105
    v_mul_f32 v106, v32, v106
    v_mul_f32 v107, v32, v107
    v_mul_f32 v108, v32, v108
    v_mul_f32 v109, v32, v109
    v_mul_f32 v110, v32, v110
    v_cvt_pk_bf16_f32 v84, v104, v105
    v_cvt_pk_bf16_f32 v85, v106, v107
    v_cvt_pk_bf16_f32 v86, v108, v109
    v_cvt_pk_bf16_f32 v87, v110, v111
    v_and_or_b32 v87, v87, s96, v34
    s_cbranch_scc0 L_slow0_1
    buffer_store_dwordx4 v[84:87], v13, s[20:23], s35 offen offset:1024
L_pub0_1:
    s_lshr_b32 s64, s53, 1
    s_lshr_b32 s65, s4, 2
    s_cmp_eq_u32 s64, s65
    s_cbranch_scc0 L_nown0
    ds_write_b128 v27, v[80:83] offset:0
    ds_write_b128 v27, v[84:87] offset:1024
L_nown0:
    v_and_b32 v131, s96, v131
    v_and_b32 v135, s96, v135
    v_and_b32 v139, s96, v139
    v_and_b32 v143, s96, v143
    v_and_b32 v147, s96, v147
    v_and_b32 v151, s96, v151
    v_and_b32 v155, s96, v155
    v_and_b32 v159, s96, v159
    v_and_b32 v163, s96, v163
    v_and_b32 v167, s96, v167
    v_and_b32 v171, s96, v171
    v_and_b32 v175, s96, v175
    v_and_b32 v179, s96, v179
    v_and_b32 v183, s96, v183
    v_and_b32 v187, s96, v187
    v_and_b32 v191, s96, v191
    s_waitcnt vmcnt(0)
    s_add_u32 s64, s28, 0
    s_add_u32 m0, s63, 0
    s_and_b32 s64, s64, 0x7fff
    s_add_u32 s64, s64, s62
    buffer_load_dwordx4 v13, s[20:23], s64 offen sc1 lds
    s_add_u32 s64, s28, 4096
    s_add_u32 m0, s63, 4096
    s_and_b32 s64, s64, 0x7fff
    s_add_u32 s64, s64, s62
    buffer_load_dwordx4 v13, s[20:23], s64 offen sc1 lds
    s_waitcnt lgkmcnt(0)
    s_barrier
    s_and_b32 s64, s4, 3
    s_lshl2_add_u32 s64, s64, s53
    s_cmp_ge_u32 s64, 14
    s_cbranch_scc1 L_idle0
    s_mov_b32 s73, 0
    ds_read_b128 v[112:115], v4 offset:0
    ds_read_b128 v[116:119], v4 offset:1024
    ds_read_b128 v[120:123], v4 offset:2048
    ds_read_b128 v[124:127], v4 offset:3072
    ds_read_b64_tr_b16 v[192:193], v20 offset:0
    ds_read_b64_tr_b16 v[194:195], v20 offset:1024
    ds_read_b64_tr_b16 v[196:197], v21 offset:0
    ds_read_b64_tr_b16 v[198:199], v21 offset:1024
    ds_read_b64_tr_b16 v[200:201], v20 offset:7168
    ds_read_b64_tr_b16 v[202:203], v20 offset:8192
    ds_read_b64_tr_b16 v[204:205], v21 offset:7168
    ds_read_b64_tr_b16 v[206:207], v21 offset:8192
    s_waitcnt lgkmcnt(11)
    v_mfma_f32_32x32x16_bf16 v[64:79], v[128:131], v[112:115], 0
    s_add_u32 s64, s28, 8192
    s_add_u32 m0, s63, 8192
    s_and_b32 s64, s64, 0x7fff
    s_add_u32 s64, s64, s62
    buffer_load_dwordx4 v13, s[20:23], s64 offen sc1 lds
    s_add_u32 s64, s28, 12288
    s_add_u32 m0, s63, 12288
    s_and_b32 s64, s64, 0x7fff
    s_add_u32 s64, s64, s62
    buffer_load_dwordx4 v13, s[20:23], s64 offen sc1 lds
    s_waitcnt lgkmcnt(10)
    v_mfma_f32_32x32x16_bf16 v[64:79], v[132:135], v[116:119], v[64:79]
    s_add_u32 s64, s28, 16384
    s_add_u32 m0, s63, 16384
    s_and_b32 s64, s64, 0x7fff
    s_add_u32 s64, s64, s62
    buffer_load_dwordx4 v13, s[20:23], s64 offen sc1 lds
    s_waitcnt lgkmcnt(9)
    v_mfma_f32_32x32x16_bf16 v[64:79], v[136:139], v[120:123], v[64:79]
    s_add_u32 s64, s28, 20480
    s_add_u32 m0, s63, 20480
    s_and_b32 s64, s64, 0x7fff
    s_add_u32 s64, s64, s62
    buffer_load_dwordx4 v13, s[20:23], s64 offen sc1 lds
    s_waitcnt lgkmcnt(8)
    v_mfma_f32_32x32x16_bf16 v[64:79], v[140:143], v[124:127], v[64:79]
    s_add_u32 s64, s28, 24576
    s_add_u32 m0, s63, 24576
    s_and_b32 s64, s64, 0x7fff
    s_add_u32 s64, s64, s62
    buffer_load_dwordx4 v13, s[20:23], s64 offen sc1 lds
    ds_read_b64_tr_b16 v[208:209], v20 offset:14336
    ds_read_b64_tr_b16 v[210:211], v20 offset:15360
    ds_read_b64_tr_b16 v[212:213], v21 offset:14336
    ds_read_b64_tr_b16 v[214:215], v21 offset:15360
    s_waitcnt lgkmcnt(8)
    v_and_b32 v195, s96, v195
    v_and_b32 v199, s96, v199
    ds_read_b64_tr_b16 v[216:217], v20 offset:21504
    ds_read_b64_tr_b16 v[218:219], v20 offset:22528
    ds_read_b64_tr_b16 v[220:221], v21 offset:21504
    ds_read_b64_tr_b16 v[222:223], v21 offset:22528
    v_and_b32 v44, 31, v1
    v_lshrrev_b32 v45, 5, v1
    v_mul_u32_u24 v44, 272, v44
    v_lshl_add_u32 v44, v45, 3, v44
    s_mul_i32 s48, s52, 8704
    s_waitcnt lgkmcnt(8)
    v_and_b32 v203, s96, v203
    v_and_b32 v207, s96, v207
    ds_read_b64_tr_b16 v[224:225], v20 offset:28672
    ds_read_b64_tr_b16 v[226:227], v20 offset:29696
    ds_read_b64_tr_b16 v[228:229], v21 offset:28672
    ds_read_b64_tr_b16 v[230:231], v21 offset:29696
    s_lshl_b32 s49, s53, 6
    s_add_u32 s48, s48, s49
    s_add_u32 s48, s48, 92160
    v_add_u32 v26, s48, v44
    v_lshrrev_b32 v46, 4, v0
    s_waitcnt lgkmcnt(8)
    v_and_b32 v211, s96, v211
    v_and_b32 v215, s96, v215
    ds_read_b64_tr_b16 v[232:233], v20 offset:35840
    ds_read_b64_tr_b16 v[234:235], v20 offset:36864
    ds_read_b64_tr_b16 v[236:237], v21 offset:35840
    ds_read_b64_tr_b16 v[238:239], v21 offset:36864
    v_and_b32 v47, 15, v0
    v_lshlrev_b32 v45, 4, v47
    v_mul_u32_u24 v27, 272, v46
    s_mov_b32 s48, 92160
    v_add3_u32 v27, v27, v45, s48
    s_waitcnt lgkmcnt(8)
    v_and_b32 v219, s96, v219
    v_and_b32 v223, s96, v223
    ds_read_b64_tr_b16 v[240:241], v22 offset:0
    ds_read_b64_tr_b16 v[242:243], v22 offset:1024
    ds_read_b64_tr_b16 v[244:245], v23 offset:0
    ds_read_b64_tr_b16 v[246:247], v23 offset:1024
    v_mul_u32_u24 v28, 1792, v46
    v_add_u32 v28, v28, v45
    s_and_b32 s49, s4, 3
    s_cmp_eq_u32 s49, 3
    s_cselect_b32 s48, 8, 16
    s_waitcnt lgkmcnt(8)
    v_and_b32 v227, s96, v227
    v_and_b32 v231, s96, v231
    ds_read_b64_tr_b16 v[248:249], v22 offset:7168
    ds_read_b64_tr_b16 v[250:251], v22 offset:8192
    ds_read_b64_tr_b16 v[252:253], v23 offset:7168
    ds_read_b64_tr_b16 v[254:255], v23 offset:8192
    v_cmp_le_u32 s[50:51], s48, v47
    v_mov_b32 v45, 0x40000000
    s_lshl_b32 s97, s34, 1
    s_lshr_b32 s48, s4, 2
    v_cndmask_b32_e64 v28, v28, v45, s[50:51]
    s_waitcnt lgkmcnt(8)
    v_and_b32 v235, s96, v235
    v_and_b32 v239, s96, v239
    s_add_u32 s97, s97, s48
    s_mul_i32 s97, s97, 114688
    s_lshl_b32 s48, s49, 8
    s_add_u32 s97, s97, s48
    s_add_u32 s97, s97, 0
    s_waitcnt lgkmcnt(4)
    v_and_b32 v243, s96, v243
    v_and_b32 v247, s96, v247
    s_add_u32 s58, s97, 57344
    s_waitcnt lgkmcnt(0)
    v_and_b32 v251, s96, v251
    v_and_b32 v255, s96, v255
    s_waitcnt vmcnt(5)
    ds_read_b32 v32, v15 offset:12
    ds_read_b32 v33, v15 offset:4108
    s_waitcnt lgkmcnt(0)
L_h2_0_0:
    v_xor_b32 v32, s57, v32
    v_bitop3_b32 v32, v32, s57, v33 bitop3:0xf6
    v_cmp_lt_u32 vcc, s96, v32
    s_cbranch_vccz L_h2x_0_0
    s_add_u32 s73, s73, 1
    s_cmp_ge_u32 s73, 100000
    s_cbranch_scc1 L_h2x_0_0
    s_add_u32 s64, s28, 0
    s_add_u32 m0, s63, 0
    s_and_b32 s64, s64, 0x7fff
    s_add_u32 s64, s64, s62
    buffer_load_dwordx4 v13, s[20:23], s64 offen sc1 lds
    s_add_u32 s64, s28, 4096
    s_add_u32 m0, s63, 4096
    s_and_b32 s64, s64, 0x7fff
    s_add_u32 s64, s64, s62
    buffer_load_dwordx4 v13, s[20:23], s64 offen sc1 lds
    s_add_u32 s64, s28, 8192
    s_add_u32 m0, s63, 8192
    s_and_b32 s64, s64, 0x7fff
    s_add_u32 s64, s64, s62
    buffer_load_dwordx4 v13, s[20:23], s64 offen sc1 lds
    s_add_u32 s64, s28, 12288
    s_add_u32 m0, s63, 12288
    s_and_b32 s64, s64, 0x7fff
    s_add_u32 s64, s64, s62
    buffer_load_dwordx4 v13, s[20:23], s64 offen sc1 lds
    s_add_u32 s64, s28, 16384
    s_add_u32 m0, s63, 16384
    s_and_b32 s64, s64, 0x7fff
    s_add_u32 s64, s64, s62
    buffer_load_dwordx4 v13, s[20:23], s64 offen sc1 lds
    s_add_u32 s64, s28, 20480
    s_add_u32 m0, s63, 20480
    s_and_b32 s64, s64, 0x7fff
    s_add_u32 s64, s64, s62
    buffer_load_dwordx4 v13, s[20:23], s64 offen sc1 lds
    s_add_u32 s64, s28, 24576
    s_add_u32 m0, s63, 24576
    s_and_b32 s64, s64, 0x7fff
    s_add_u32 s64, s64, s62
    buffer_load_dwordx4 v13, s[20:23], s64 offen sc1 lds
    s_waitcnt vmcnt(5)
    ds_read_b32 v32, v15 offset:12
    ds_read_b32 v33, v15 offset:4108
    s_waitcnt lgkmcnt(0)
    s_branch L_h2_0_0
L_h2x_0_0:
    s_barrier
    ds_read_b128 v[112:115], v4 offset:4096
    ds_read_b128 v[116:119], v4 offset:5120
    ds_read_b128 v[120:123], v4 offset:6144
    ds_read_b128 v[124:127], v4 offset:7168
    s_waitcnt lgkmcnt(3)
    v_mfma_f32_32x32x16_bf16 v[64:79], v[144:147], v[112:115], v[64:79]
    ds_read_b128 v[112:115], v4 offset:8192
    s_waitcnt lgkmcnt(3)
    v_mfma_f32_32x32x16_bf16 v[64:79], v[148:151], v[116:119], v[64:79]
    s_waitcnt vmcnt(3)
    ds_read_b32 v32, v15 offset:8204
    ds_read_b32 v33, v15 offset:12300
    ds_read_b128 v[116:119], v4 offset:9216
    s_waitcnt lgkmcnt(5)
    v_mfma_f32_32x32x16_bf16 v[64:79], v[152:155], v[120:123], v[64:79]
    ds_read_b128 v[120:123], v4 offset:10240
    s_waitcnt lgkmcnt(5)
    v_mfma_f32_32x32x16_bf16 v[64:79], v[156:159], v[124:127], v[64:79]
    ds_read_b128 v[124:127], v4 offset:11264
    s_waitcnt lgkmcnt(5)
    v_mfma_f32_32x32x16_bf16 v[64:79], v[160:163], v[112:115], v[64:79]
    s_waitcnt lgkmcnt(3)
L_h2_0_1:
    v_xor_b32 v32, s57, v32
    v_bitop3_b32 v32, v32, s57, v33 bitop3:0xf6
    v_cmp_lt_u32 vcc, s96, v32
    s_cbranch_vccz L_h2x_0_1
    s_add_u32 s73, s73, 1
    s_cmp_ge_u32 s73, 100000
    s_cbranch_scc1 L_h2x_0_1
    s_add_u32 s64, s28, 8192
    s_add_u32 m0, s63, 8192
    s_and_b32 s64, s64, 0x7fff
    s_add_u32 s64, s64, s62
    buffer_load_dwordx4 v13, s[20:23], s64 offen sc1 lds
    s_add_u32 s64, s28, 12288
    s_add_u32 m0, s63, 12288
    s_and_b32 s64, s64, 0x7fff
    s_add_u32 s64, s64, s62
    buffer_load_dwordx4 v13, s[20:23], s64 offen sc1 lds
    s_add_u32 s64, s28, 16384
    s_add_u32 m0, s63, 16384
    s_and_b32 s64, s64, 0x7fff
    s_add_u32 s64, s64, s62
    buffer_load_dwordx4 v13, s[20:23], s64 offen sc1 lds
    s_add_u32 s64, s28, 20480
    s_add_u32 m0, s63, 20480
    s_and_b32 s64, s64, 0x7fff
    s_add_u32 s64, s64, s62
    buffer_load_dwordx4 v13, s[20:23], s64 offen sc1 lds
    s_add_u32 s64, s28, 24576
    s_add_u32 m0, s63, 24576
    s_and_b32 s64, s64, 0x7fff
    s_add_u32 s64, s64, s62
    buffer_load_dwordx4 v13, s[20:23], s64 offen sc1 lds
    s_waitcnt vmcnt(3)
    ds_read_b32 v32, v15 offset:8204
    ds_read_b32 v33, v15 offset:12300
    s_waitcnt lgkmcnt(0)
    s_branch L_h2_0_1
L_h2x_0_1:
    s_barrier
    ds_read_b128 v[112:115], v4 offset:12288
    s_waitcnt lgkmcnt(3)
    v_mfma_f32_32x32x16_bf16 v[64:79], v[164:167], v[116:119], v[64:79]
    ds_read_b128 v[116:119], v4 offset:13312
    s_waitcnt lgkmcnt(3)
    v_mfma_f32_32x32x16_bf16 v[64:79], v[168:171], v[120:123], v[64:79]
    ds_read_b128 v[120:123], v4 offset:14336
    s_waitcnt lgkmcnt(3)
    v_mfma_f32_32x32x16_bf16 v[64:79], v[172:175], v[124:127], v[64:79]
    ds_read_b128 v[124:127], v4 offset:15360
    s_waitcnt lgkmcnt(3)
    v_mfma_f32_32x32x16_bf16 v[64:79], v[176:179], v[112:115], v[64:79]
    ds_read_b128 v[112:115], v4 offset:16384
    s_waitcnt lgkmcnt(3)
    v_mfma_f32_32x32x16_bf16 v[64:79], v[180:183], v[116:119], v[64:79]
    s_waitcnt vmcnt(0)
    ds_read_b32 v32, v15 offset:16396
    ds_read_b32 v33, v15 offset:20492
    ds_read_b32 v35, v15 offset:24588
    ds_read_b128 v[116:119], v4 offset:17408
    s_waitcnt lgkmcnt(6)
    v_mfma_f32_32x32x16_bf16 v[64:79], v[184:187], v[120:123], v[64:79]
    ds_read_b128 v[120:123], v4 offset:18432
    s_waitcnt lgkmcnt(6)
    v_mfma_f32_32x32x16_bf16 v[64:79], v[188:191], v[124:127], v[64:79]
    ds_read_b128 v[124:127], v4 offset:19456
    s_waitcnt lgkmcnt(6)
    v_mfma_f32_32x32x16_bf16 v[64:79], v[192:195], v[112:115], v[64:79]
    s_waitcnt lgkmcnt(3)
L_h2_0_2:
    v_xor_b32 v32, s57, v32
    v_bitop3_b32 v32, v32, s57, v33 bitop3:0xf6
    v_bitop3_b32 v32, v32, s57, v35 bitop3:0xf6
    v_cmp_lt_u32 vcc, s96, v32
    s_cbranch_vccz L_h2x_0_2
    s_add_u32 s73, s73, 1
    s_cmp_ge_u32 s73, 100000
    s_cbranch_scc1 L_h2x_0_2
    s_add_u32 s64, s28, 16384
    s_add_u32 m0, s63, 16384
    s_and_b32 s64, s64, 0x7fff
    s_add_u32 s64, s64, s62
    buffer_load_dwordx4 v13, s[20:23], s64 offen sc1 lds
    s_add_u32 s64, s28, 20480
    s_add_u32 m0, s63, 20480
    s_and_b32 s64, s64, 0x7fff
    s_add_u32 s64, s64, s62
    buffer_load_dwordx4 v13, s[20:23], s64 offen sc1 lds
    s_add_u32 s64, s28, 24576
    s_add_u32 m0, s63, 24576
    s_and_b32 s64, s64, 0x7fff
    s_add_u32 s64, s64, s62
    buffer_load_dwordx4 v13, s[20:23], s64 offen sc1 lds
    s_waitcnt vmcnt(0)
    ds_read_b32 v32, v15 offset:16396
    ds_read_b32 v33, v15 offset:20492
    ds_read_b32 v35, v15 offset:24588
    s_waitcnt lgkmcnt(0)
    s_branch L_h2_0_2
L_h2x_0_2:
    s_barrier
    ds_read_b128 v[112:115], v4 offset:20480
    s_waitcnt lgkmcnt(3)
    v_mfma_f32_32x32x16_bf16 v[64:79], v[196:199], v[116:119], v[64:79]
    ds_read_b128 v[116:119], v4 offset:21504
    s_waitcnt lgkmcnt(3)
    v_mfma_f32_32x32x16_bf16 v[64:79], v[200:203], v[120:123], v[64:79]
    ds_read_b128 v[120:123], v4 offset:22528
    s_waitcnt lgkmcnt(3)
    v_mfma_f32_32x32x16_bf16 v[64:79], v[204:207], v[124:127], v[64:79]
    ds_read_b128 v[124:127], v4 offset:23552
    s_waitcnt lgkmcnt(3)
    v_mfma_f32_32x32x16_bf16 v[64:79], v[208:211], v[112:115], v[64:79]
    ds_read_b128 v[112:115], v4 offset:24576
    s_waitcnt lgkmcnt(3)
    v_mfma_f32_32x32x16_bf16 v[64:79], v[212:215], v[116:119], v[64:79]
    ds_read_b128 v[116:119], v4 offset:25600
    s_waitcnt lgkmcnt(3)
    v_mfma_f32_32x32x16_bf16 v[64:79], v[216:219], v[120:123], v[64:79]
    ds_read_b128 v[120:123], v4 offset:26624
    s_waitcnt lgkmcnt(3)
    v_mfma_f32_32x32x16_bf16 v[64:79], v[220:223], v[124:127], v[64:79]
    ds_read_b128 v[124:127], v4 offset:27648
    s_waitcnt lgkmcnt(3)
    v_mfma_f32_32x32x16_bf16 v[64:79], v[224:227], v[112:115], v[64:79]
    ds_read_b128 v[112:115], v4 offset:28672
    s_waitcnt lgkmcnt(3)
    v_mfma_f32_32x32x16_bf16 v[64:79], v[228:231], v[116:119], v[64:79]
    ds_read_b128 v[116:119], v4 offset:29696
    s_waitcnt lgkmcnt(3)
    v_mfma_f32_32x32x16_bf16 v[64:79], v[232:235], v[120:123], v[64:79]
    ds_read_b128 v[120:123], v4 offset:30720
    s_waitcnt lgkmcnt(3)
    v_mfma_f32_32x32x16_bf16 v[64:79], v[236:239], v[124:127], v[64:79]
    ds_read_b128 v[124:127], v4 offset:31744
    s_waitcnt lgkmcnt(3)
    v_mfma_f32_32x32x16_bf16 v[64:79], v[240:243], v[112:115], v[64:79]
    s_waitcnt lgkmcnt(2)
    v_mfma_f32_32x32x16_bf16 v[64:79], v[244:247], v[116:119], v[64:79]
    s_or_b32 s64, s3, s32
    s_cmp_eq_u32 s64, 0
    s_cbranch_scc0 L_noe0
    s_or_b32 s64, s56, s57
    v_mov_b32 v32, s64
    v_mov_b32 v33, 0
    s_mov_b64 exec, 1
    buffer_store_dword v32, v33, s[20:23], 0 offen sc1
    s_mov_b64 exec, -1
L_noe0:
    s_waitcnt lgkmcnt(1)
    v_mfma_f32_32x32x16_bf16 v[64:79], v[248:251], v[120:123], v[64:79]
    s_waitcnt lgkmcnt(0)
    v_mfma_f32_32x32x16_bf16 v[64:79], v[252:255], v[124:127], v[64:79]
    s_nop 11
    v_cvt_pk_bf16_f32 v88, v64, v65
    v_cvt_pk_bf16_f32 v89, v66, v67
    ds_write_b64 v26, v[88:89] offset:0
    v_cvt_pk_bf16_f32 v90, v68, v69
    v_cvt_pk_bf16_f32 v91, v70, v71
    ds_write_b64 v26, v[90:91] offset:16
    v_cvt_pk_bf16_f32 v92, v72, v73
    v_cvt_pk_bf16_f32 v93, v74, v75
    ds_write_b64 v26, v[92:93] offset:32
    v_cvt_pk_bf16_f32 v94, v76, v77
    v_cvt_pk_bf16_f32 v95, v78, v79
    ds_write_b64 v26, v[94:95] offset:48
L_join0:
    s_waitcnt lgkmcnt(0)
    s_barrier
    ds_read_b128 v[96:99], v27
    ds_read_b128 v[100:103], v27 offset:8704
    s_waitcnt lgkmcnt(1)
    buffer_store_dwordx4 v[96:99], v28, s[24:27], s97 offen sc1
    s_waitcnt lgkmcnt(0)
    buffer_store_dwordx4 v[100:103], v28, s[24:27], s58 offen sc1
    s_endpgm
L_idle0:
    v_and_b32 v44, 31, v1
    v_lshrrev_b32 v45, 5, v1
    v_mul_u32_u24 v44, 272, v44
    v_lshl_add_u32 v44, v45, 3, v44
    s_mul_i32 s48, s52, 8704
    s_lshl_b32 s49, s53, 6
    s_add_u32 s48, s48, s49
    s_add_u32 s48, s48, 92160
    v_add_u32 v26, s48, v44
    v_lshrrev_b32 v46, 4, v0
    v_and_b32 v47, 15, v0
    v_lshlrev_b32 v45, 4, v47
    v_mul_u32_u24 v27, 272, v46
    s_mov_b32 s48, 92160
    v_add3_u32 v27, v27, v45, s48
    v_mul_u32_u24 v28, 1792, v46
    v_add_u32 v28, v28, v45
    s_and_b32 s49, s4, 3
    s_cmp_eq_u32 s49, 3
    s_cselect_b32 s48, 8, 16
    v_cmp_le_u32 s[50:51], s48, v47
    v_mov_b32 v45, 0x40000000
    s_lshl_b32 s97, s34, 1
    s_lshr_b32 s48, s4, 2
    v_cndmask_b32_e64 v28, v28, v45, s[50:51]
    s_add_u32 s97, s97, s48
    s_mul_i32 s97, s97, 114688
    s_lshl_b32 s48, s49, 8
    s_add_u32 s97, s97, s48
    s_add_u32 s97, s97, 0
    s_add_u32 s58, s97, 57344
    s_mov_b32 s73, 0
    s_lshl_b32 s64, s4, 3
    s_add_u32 s64, s64, s32
    s_lshl_b32 s65, s101, 8
    s_add_u32 s64, s64, s65
    s_cmp_eq_u32 s64, 26
    s_cbranch_scc0 L_idle20
    s_add_u32 s64, s28, 8192
    s_add_u32 m0, s63, 8192
    s_and_b32 s64, s64, 0x7fff
    s_add_u32 s64, s64, s62
    buffer_load_dwordx4 v13, s[20:23], s64 offen sc1 lds
    s_add_u32 s64, s28, 12288
    s_add_u32 m0, s63, 12288
    s_and_b32 s64, s64, 0x7fff
    s_add_u32 s64, s64, s62
    buffer_load_dwordx4 v13, s[20:23], s64 offen sc1 lds
    s_add_u32 s64, s28, 16384
    s_add_u32 m0, s63, 16384
    s_and_b32 s64, s64, 0x7fff
    s_add_u32 s64, s64, s62
    buffer_load_dwordx4 v13, s[20:23], s64 offen sc1 lds
    s_add_u32 s64, s28, 20480
    s_add_u32 m0, s63, 20480
    s_and_b32 s64, s64, 0x7fff
    s_add_u32 s64, s64, s62
    buffer_load_dwordx4 v13, s[20:23], s64 offen sc1 lds
    s_add_u32 s64, s28, 24576
    s_add_u32 m0, s63, 24576
    s_and_b32 s64, s64, 0x7fff
    s_add_u32 s64, s64, s62
    buffer_load_dwordx4 v13, s[20:23], s64 offen sc1 lds
    s_waitcnt vmcnt(5)
    ds_read_b32 v32, v15 offset:12
    ds_read_b32 v33, v15 offset:4108
    s_waitcnt lgkmcnt(0)
L_h2_0iw_0:
    v_xor_b32 v32, s57, v32
    v_bitop3_b32 v32, v32, s57, v33 bitop3:0xf6
    v_cmp_lt_u32 vcc, s96, v32
    s_cbranch_vccz L_h2x_0iw_0
    s_add_u32 s73, s73, 1
    s_cmp_ge_u32 s73, 100000
    s_cbranch_scc1 L_h2x_0iw_0
    s_add_u32 s64, s28, 0
    s_add_u32 m0, s63, 0
    s_and_b32 s64, s64, 0x7fff
    s_add_u32 s64, s64, s62
    buffer_load_dwordx4 v13, s[20:23], s64 offen sc1 lds
    s_add_u32 s64, s28, 4096
    s_add_u32 m0, s63, 4096
    s_and_b32 s64, s64, 0x7fff
    s_add_u32 s64, s64, s62
    buffer_load_dwordx4 v13, s[20:23], s64 offen sc1 lds
    s_add_u32 s64, s28, 8192
    s_add_u32 m0, s63, 8192
    s_and_b32 s64, s64, 0x7fff
    s_add_u32 s64, s64, s62
    buffer_load_dwordx4 v13, s[20:23], s64 offen sc1 lds
    s_add_u32 s64, s28, 12288
    s_add_u32 m0, s63, 12288
    s_and_b32 s64, s64, 0x7fff
    s_add_u32 s64, s64, s62
    buffer_load_dwordx4 v13, s[20:23], s64 offen sc1 lds
    s_add_u32 s64, s28, 16384
    s_add_u32 m0, s63, 16384
    s_and_b32 s64, s64, 0x7fff
    s_add_u32 s64, s64, s62
    buffer_load_dwordx4 v13, s[20:23], s64 offen sc1 lds
    s_add_u32 s64, s28, 20480
    s_add_u32 m0, s63, 20480
    s_and_b32 s64, s64, 0x7fff
    s_add_u32 s64, s64, s62
    buffer_load_dwordx4 v13, s[20:23], s64 offen sc1 lds
    s_add_u32 s64, s28, 24576
    s_add_u32 m0, s63, 24576
    s_and_b32 s64, s64, 0x7fff
    s_add_u32 s64, s64, s62
    buffer_load_dwordx4 v13, s[20:23], s64 offen sc1 lds
    s_waitcnt vmcnt(0)
    ds_read_b32 v32, v15 offset:12
    ds_read_b32 v33, v15 offset:4108
    s_waitcnt lgkmcnt(0)
    s_branch L_h2_0iw_0
L_h2x_0iw_0:
    s_barrier
    s_waitcnt vmcnt(3)
    ds_read_b32 v32, v15 offset:8204
    ds_read_b32 v33, v15 offset:12300
    s_waitcnt lgkmcnt(0)
L_h2_0iw_1:
    v_xor_b32 v32, s57, v32
    v_bitop3_b32 v32, v32, s57, v33 bitop3:0xf6
    v_cmp_lt_u32 vcc, s96, v32
    s_cbranch_vccz L_h2x_0iw_1
    s_add_u32 s73, s73, 1
    s_cmp_ge_u32 s73, 100000
    s_cbranch_scc1 L_h2x_0iw_1
    s_add_u32 s64, s28, 8192
    s_add_u32 m0, s63, 8192
    s_and_b32 s64, s64, 0x7fff
    s_add_u32 s64, s64, s62
    buffer_load_dwordx4 v13, s[20:23], s64 offen sc1 lds
    s_add_u32 s64, s28, 12288
    s_add_u32 m0, s63, 12288
    s_and_b32 s64, s64, 0x7fff
    s_add_u32 s64, s64, s62
    buffer_load_dwordx4 v13, s[20:23], s64 offen sc1 lds
    s_add_u32 s64, s28, 16384
    s_add_u32 m0, s63, 16384
    s_and_b32 s64, s64, 0x7fff
    s_add_u32 s64, s64, s62
    buffer_load_dwordx4 v13, s[20:23], s64 offen sc1 lds
    s_add_u32 s64, s28, 20480
    s_add_u32 m0, s63, 20480
    s_and_b32 s64, s64, 0x7fff
    s_add_u32 s64, s64, s62
    buffer_load_dwordx4 v13, s[20:23], s64 offen sc1 lds
    s_add_u32 s64, s28, 24576
    s_add_u32 m0, s63, 24576
    s_and_b32 s64, s64, 0x7fff
    s_add_u32 s64, s64, s62
    buffer_load_dwordx4 v13, s[20:23], s64 offen sc1 lds
    s_waitcnt vmcnt(0)
    ds_read_b32 v32, v15 offset:8204
    ds_read_b32 v33, v15 offset:12300
    s_waitcnt lgkmcnt(0)
    s_branch L_h2_0iw_1
L_h2x_0iw_1:
    s_barrier
    s_waitcnt vmcnt(0)
    ds_read_b32 v32, v15 offset:16396
    ds_read_b32 v33, v15 offset:20492
    ds_read_b32 v35, v15 offset:24588
    s_waitcnt lgkmcnt(0)
L_h2_0iw_2:
    v_xor_b32 v32, s57, v32
    v_bitop3_b32 v32, v32, s57, v33 bitop3:0xf6
    v_bitop3_b32 v32, v32, s57, v35 bitop3:0xf6
    v_cmp_lt_u32 vcc, s96, v32
    s_cbranch_vccz L_h2x_0iw_2
    s_add_u32 s73, s73, 1
    s_cmp_ge_u32 s73, 100000
    s_cbranch_scc1 L_h2x_0iw_2
    s_add_u32 s64, s28, 16384
    s_add_u32 m0, s63, 16384
    s_and_b32 s64, s64, 0x7fff
    s_add_u32 s64, s64, s62
    buffer_load_dwordx4 v13, s[20:23], s64 offen sc1 lds
    s_add_u32 s64, s28, 20480
    s_add_u32 m0, s63, 20480
    s_and_b32 s64, s64, 0x7fff
    s_add_u32 s64, s64, s62
    buffer_load_dwordx4 v13, s[20:23], s64 offen sc1 lds
    s_add_u32 s64, s28, 24576
    s_add_u32 m0, s63, 24576
    s_and_b32 s64, s64, 0x7fff
    s_add_u32 s64, s64, s62
    buffer_load_dwordx4 v13, s[20:23], s64 offen sc1 lds
    s_waitcnt vmcnt(0)
    ds_read_b32 v32, v15 offset:16396
    ds_read_b32 v33, v15 offset:20492
    ds_read_b32 v35, v15 offset:24588
    s_waitcnt lgkmcnt(0)
    s_branch L_h2_0iw_2
L_h2x_0iw_2:
    s_barrier
    buffer_wbl2 sc1
    s_branch L_join0
L_idle20:
    s_add_u32 s64, s28, 8192
    s_add_u32 m0, s63, 8192
    s_and_b32 s64, s64, 0x7fff
    s_add_u32 s64, s64, s62
    buffer_load_dwordx4 v13, s[20:23], s64 offen sc1 lds
    s_add_u32 s64, s28, 12288
    s_add_u32 m0, s63, 12288
    s_and_b32 s64, s64, 0x7fff
    s_add_u32 s64, s64, s62
    buffer_load_dwordx4 v13, s[20:23], s64 offen sc1 lds
    s_add_u32 s64, s28, 16384
    s_add_u32 m0, s63, 16384
    s_and_b32 s64, s64, 0x7fff
    s_add_u32 s64, s64, s62
    buffer_load_dwordx4 v13, s[20:23], s64 offen sc1 lds
    s_add_u32 s64, s28, 20480
    s_add_u32 m0, s63, 20480
    s_and_b32 s64, s64, 0x7fff
    s_add_u32 s64, s64, s62
    buffer_load_dwordx4 v13, s[20:23], s64 offen sc1 lds
    s_add_u32 s64, s28, 24576
    s_add_u32 m0, s63, 24576
    s_and_b32 s64, s64, 0x7fff
    s_add_u32 s64, s64, s62
    buffer_load_dwordx4 v13, s[20:23], s64 offen sc1 lds
    s_waitcnt vmcnt(5)
    ds_read_b32 v32, v15 offset:12
    ds_read_b32 v33, v15 offset:4108
    s_waitcnt lgkmcnt(0)
L_h2_0i_0:
    v_xor_b32 v32, s57, v32
    v_bitop3_b32 v32, v32, s57, v33 bitop3:0xf6
    v_cmp_lt_u32 vcc, s96, v32
    s_cbranch_vccz L_h2x_0i_0
    s_add_u32 s73, s73, 1
    s_cmp_ge_u32 s73, 100000
    s_cbranch_scc1 L_h2x_0i_0
    s_add_u32 s64, s28, 0
    s_add_u32 m0, s63, 0
    s_and_b32 s64, s64, 0x7fff
    s_add_u32 s64, s64, s62
    buffer_load_dwordx4 v13, s[20:23], s64 offen sc1 lds
    s_add_u32 s64, s28, 4096
    s_add_u32 m0, s63, 4096
    s_and_b32 s64, s64, 0x7fff
    s_add_u32 s64, s64, s62
    buffer_load_dwordx4 v13, s[20:23], s64 offen sc1 lds
    s_add_u32 s64, s28, 8192
    s_add_u32 m0, s63, 8192
    s_and_b32 s64, s64, 0x7fff
    s_add_u32 s64, s64, s62
    buffer_load_dwordx4 v13, s[20:23], s64 offen sc1 lds
    s_add_u32 s64, s28, 12288
    s_add_u32 m0, s63, 12288
    s_and_b32 s64, s64, 0x7fff
    s_add_u32 s64, s64, s62
    buffer_load_dwordx4 v13, s[20:23], s64 offen sc1 lds
    s_add_u32 s64, s28, 16384
    s_add_u32 m0, s63, 16384
    s_and_b32 s64, s64, 0x7fff
    s_add_u32 s64, s64, s62
    buffer_load_dwordx4 v13, s[20:23], s64 offen sc1 lds
    s_add_u32 s64, s28, 20480
    s_add_u32 m0, s63, 20480
    s_and_b32 s64, s64, 0x7fff
    s_add_u32 s64, s64, s62
    buffer_load_dwordx4 v13, s[20:23], s64 offen sc1 lds
    s_add_u32 s64, s28, 24576
    s_add_u32 m0, s63, 24576
    s_and_b32 s64, s64, 0x7fff
    s_add_u32 s64, s64, s62
    buffer_load_dwordx4 v13, s[20:23], s64 offen sc1 lds
    s_waitcnt vmcnt(5)
    ds_read_b32 v32, v15 offset:12
    ds_read_b32 v33, v15 offset:4108
    s_waitcnt lgkmcnt(0)
    s_branch L_h2_0i_0
L_h2x_0i_0:
    s_barrier
    s_waitcnt vmcnt(3)
    ds_read_b32 v32, v15 offset:8204
    ds_read_b32 v33, v15 offset:12300
    s_waitcnt lgkmcnt(0)
L_h2_0i_1:
    v_xor_b32 v32, s57, v32
    v_bitop3_b32 v32, v32, s57, v33 bitop3:0xf6
    v_cmp_lt_u32 vcc, s96, v32
    s_cbranch_vccz L_h2x_0i_1
    s_add_u32 s73, s73, 1
    s_cmp_ge_u32 s73, 100000
    s_cbranch_scc1 L_h2x_0i_1
    s_add_u32 s64, s28, 8192
    s_add_u32 m0, s63, 8192
    s_and_b32 s64, s64, 0x7fff
    s_add_u32 s64, s64, s62
    buffer_load_dwordx4 v13, s[20:23], s64 offen sc1 lds
    s_add_u32 s64, s28, 12288
    s_add_u32 m0, s63, 12288
    s_and_b32 s64, s64, 0x7fff
    s_add_u32 s64, s64, s62
    buffer_load_dwordx4 v13, s[20:23], s64 offen sc1 lds
    s_add_u32 s64, s28, 16384
    s_add_u32 m0, s63, 16384
    s_and_b32 s64, s64, 0x7fff
    s_add_u32 s64, s64, s62
    buffer_load_dwordx4 v13, s[20:23], s64 offen sc1 lds
    s_add_u32 s64, s28, 20480
    s_add_u32 m0, s63, 20480
    s_and_b32 s64, s64, 0x7fff
    s_add_u32 s64, s64, s62
    buffer_load_dwordx4 v13, s[20:23], s64 offen sc1 lds
    s_add_u32 s64, s28, 24576
    s_add_u32 m0, s63, 24576
    s_and_b32 s64, s64, 0x7fff
    s_add_u32 s64, s64, s62
    buffer_load_dwordx4 v13, s[20:23], s64 offen sc1 lds
    s_waitcnt vmcnt(3)
    ds_read_b32 v32, v15 offset:8204
    ds_read_b32 v33, v15 offset:12300
    s_waitcnt lgkmcnt(0)
    s_branch L_h2_0i_1
L_h2x_0i_1:
    s_barrier
    s_waitcnt vmcnt(0)
    ds_read_b32 v32, v15 offset:16396
    ds_read_b32 v33, v15 offset:20492
    ds_read_b32 v35, v15 offset:24588
    s_waitcnt lgkmcnt(0)
L_h2_0i_2:
    v_xor_b32 v32, s57, v32
    v_bitop3_b32 v32, v32, s57, v33 bitop3:0xf6
    v_bitop3_b32 v32, v32, s57, v35 bitop3:0xf6
    v_cmp_lt_u32 vcc, s96, v32
    s_cbranch_vccz L_h2x_0i_2
    s_add_u32 s73, s73, 1
    s_cmp_ge_u32 s73, 100000
    s_cbranch_scc1 L_h2x_0i_2
    s_add_u32 s64, s28, 16384
    s_add_u32 m0, s63, 16384
    s_and_b32 s64, s64, 0x7fff
    s_add_u32 s64, s64, s62
    buffer_load_dwordx4 v13, s[20:23], s64 offen sc1 lds
    s_add_u32 s64, s28, 20480
    s_add_u32 m0, s63, 20480
    s_and_b32 s64, s64, 0x7fff
    s_add_u32 s64, s64, s62
    buffer_load_dwordx4 v13, s[20:23], s64 offen sc1 lds
    s_add_u32 s64, s28, 24576
    s_add_u32 m0, s63, 24576
    s_and_b32 s64, s64, 0x7fff
    s_add_u32 s64, s64, s62
    buffer_load_dwordx4 v13, s[20:23], s64 offen sc1 lds
    s_waitcnt vmcnt(0)
    ds_read_b32 v32, v15 offset:16396
    ds_read_b32 v33, v15 offset:20492
    ds_read_b32 v35, v15 offset:24588
    s_waitcnt lgkmcnt(0)
    s_branch L_h2_0i_2
L_h2x_0i_2:
    s_barrier
    s_nop 1
    s_branch L_join0
L_p1s0:
    buffer_store_dwordx4 v[120:123], v13, s[20:23], s64 offen sc1
    s_nop 1
    s_branch L_p1j0
L_slow0_0:
    buffer_store_dwordx4 v[80:83], v13, s[20:23], s35 offen offset:0 sc1
    s_nop 1
    s_branch L_pub0_0
L_slow0_1:
    buffer_store_dwordx4 v[84:87], v13, s[20:23], s35 offen offset:1024 sc1
    s_nop 1
    s_branch L_pub0_1
L_end:
    s_endpgm
.section .rodata,"a"
.p2align 6
.amdhsa_kernel concat_heads__linear_attn_block__linear_kernel_hedgehog__prompt_kernel
  .amdhsa_next_free_vgpr 256
  .amdhsa_next_free_sgpr 102
  .amdhsa_accum_offset 256
  .amdhsa_group_segment_fixed_size 0
  .amdhsa_kernarg_size 80
  .amdhsa_user_sgpr_count 2
  .amdhsa_user_sgpr_kernarg_segment_ptr 1
  .amdhsa_system_sgpr_workgroup_id_x 1
.end_amdhsa_kernel
```
